```python
import torch

def _softmax(x, axis=-1):
    return torch.softmax(x, dim=axis)

def _gelu(x):
    return torch.nn.functional.gelu(x, approximate='tanh')

def _silu(x):
    return torch.nn.functional.silu(x)

def _sigmoid(x):
    return torch.sigmoid(x)

def _layernorm(x, axis=-1, eps=1e-05):
    m = x.mean(dim=axis, keepdim=True)
    v = x.var(dim=axis, keepdim=True, unbiased=False)
    return (x - m) / torch.sqrt(v + eps)

def _scatter_add(tgt, idx, src, axis=0):
    return tgt.clone().index_add_(axis, idx, src)

def _segment_sum(src, seg, n):
    out = torch.zeros((n,) + src.shape[1:], dtype=src.dtype)
    return out.index_add_(0, seg, src)

def _pad(x, pw):
    flat = tuple((v for pair in reversed(pw) for v in pair))
    return torch.nn.functional.pad(x, flat)
kernel_name = 'standalone__tensor_product_equiv_equiformer__graph'

def setup_inputs():

    _w = lambda a: (lambda t: t.to(torch.bfloat16) if t.is_floating_point() else t)(torch.as_tensor(a))
    N, deg, C, De = (50000, 16, 64, max(16, 1))
    E = N * deg
    src = (lambda lo, hi, *s: torch.randint(lo, hi, s))(0, N, E).to(torch.int64)
    dst = (lambda lo, hi, *s: torch.randint(lo, hi, s))(0, N, E).to(torch.int64)
    rvec = (lambda *s: torch.randn(*s, dtype=torch.bfloat16) * 0.05)(E, 3).to(float)
    rn = (torch.linalg.norm(rvec, dim=-1, keepdim=True) + 1e-06).to(float)
    rhat = (rvec / rn).to(float)
    eps = torch.zeros((3, 3, 3), dtype=float)
    eps[0, 1, 2] = eps[1, 2, 0] = eps[2, 0, 1] = 1.0
    eps[0, 2, 1] = eps[2, 1, 0] = eps[1, 0, 2] = -1.0
    return {'x': _w((lambda *s: torch.randn(*s, dtype=torch.bfloat16) * 0.2)(N, 4 * C).to(float)), 'rhat': _w(rhat), 'e_attr': _w((lambda *s: torch.randn(*s, dtype=torch.bfloat16) * 0.2)(E, De).to(float)), 'src': _w(src), 'dst': _w(dst), 'w_rad': _w((lambda *s: torch.randn(*s, dtype=torch.bfloat16) * 0.2)(De, 5 * C).to(float)), 'w_si0': _w((lambda *s: torch.randn(*s, dtype=torch.bfloat16) * 0.2)(2 * C, C).to(float)), 'w_si1': _w((lambda *s: torch.randn(*s, dtype=torch.bfloat16) * 0.05)(3 * C, C).to(float)), 'cg_eps': _w(eps)}

def reference(x, rhat, e_attr, src, dst, w_rad, w_si0, w_si1, cg_eps):
    N = x.shape[0]
    C = w_si0.shape[1]
    E = rhat.shape[0]
    x0 = x[:, :C].clone()
    x1 = x[:, C:].reshape(N, 3, C)
    R = (e_attr @ w_rad).reshape(E, 5, C)
    f0 = x0[src]
    f1 = x1[src]
    Y1 = rhat
    p00_0 = f0 * R[:, 0, :]
    p11_0 = torch.einsum('ejc,ej->ec', f1, Y1) * R[:, 1, :]
    p01_1 = torch.einsum('ec,ej->ejc', f0, Y1) * R[:, 2, :][:, None, :]
    p10_1 = f1 * R[:, 3, :][:, None, :]
    p11_1 = torch.einsum('ijk,ekc,ej->eic', cg_eps, f1, Y1) * R[:, 4, :][:, None, :]
    m0 = torch.concatenate([p00_0, p11_0], axis=-1) @ w_si0
    m1 = torch.einsum('ejp,pc->ejc', torch.concatenate([p01_1, p10_1, p11_1], axis=-1), w_si1)
    agg0 = _segment_sum(m0, dst, N)
    agg1 = _segment_sum(m1.reshape(E, 3 * C), dst, N).reshape(N, 3, C)
    gate = _sigmoid(agg0)
    out1 = agg1 * gate[:, None, :]
    return torch.concatenate([agg0, out1.reshape(N, 3 * C)], axis=-1)
```

```asm
; @launch kernel=part_kernel grid=(256,1,1) block=(832,1,1) lds=142848
; @launch kernel=standalone__tensor_product_equiv_equiformer__graph_kernel grid=(256,1,1) block=(512,1,1) lds=163328
.amdgcn_target "amdgcn-amd-amdhsa--gfx950"
.text
.globl part_kernel
.globl standalone__tensor_product_equiv_equiformer__graph_kernel
.p2align 8
.type part_kernel,@function
part_kernel:
    s_cmp_ge_u32 s2, 255
    s_cbranch_scc1 LA_end
    s_load_dwordx4 s[24:27], s[0:1], 8
    s_load_dwordx4 s[28:31], s[0:1], 24
    s_load_dwordx4 s[32:35], s[0:1], 40
    s_load_dwordx2 s[36:37], s[0:1], 56
    s_load_dwordx2 s[38:39], s[0:1], 88
    s_getpc_b64 s[48:49]
LA_pc0:
    v_lshlrev_b32 v62, 7, v0
    v_min_u32 v62, LA_end-LA_pc0, v62
    v_cmp_gt_u32 vcc, 24, v0
    s_and_saveexec_b64 s[50:51], vcc
    s_cbranch_execz LA_nopc0
    global_load_dword v63, v62, s[48:49]
LA_nopc0:
    s_mov_b64 exec, s[50:51]
    v_lshrrev_b32 v1, 6, v0
    v_and_b32 v2, 63, v0
    v_readfirstlane_b32 s42, v1
    s_waitcnt lgkmcnt(0)
    s_mov_b32 s20, s38
    s_mov_b32 s21, s39
    s_mov_b32 s22, 0x10000000
    s_mov_b32 s23, 0x00020000
    s_cmp_ge_u32 s2, 250
    s_cbranch_scc1 LA_weights
    s_mov_b32 s4, s30
    s_mov_b32 s5, s31
    s_mov_b32 s6, 0x30d400
    s_mov_b32 s7, 0x00020000
    s_mov_b32 s8, s28
    s_mov_b32 s9, s29
    s_mov_b32 s10, 0x30d400
    s_mov_b32 s11, 0x00020000
    s_mov_b32 s12, s24
    s_mov_b32 s13, s25
    s_mov_b32 s14, 0x493e00
    s_mov_b32 s15, 0x00020000
    s_mov_b32 s16, s26
    s_mov_b32 s17, s27
    s_mov_b32 s18, 0x186a000
    s_mov_b32 s19, 0x00020000
    s_movk_i32 s46, 800
    v_cmp_gt_u32 s[40:41], s46, v0
    s_mul_i32 s43, s2, 12800
    s_mul_i32 s44, s2, 19200
    v_lshl_add_u32 v3, v0, 4, s43
    v_mul_u32_u24 v18, 24, v0
    v_add_u32 v18, s44, v18
    s_mov_b64 exec, s[40:41]
    buffer_load_dwordx4 v[4:7], v3, s[4:7], 0 offen nt
    s_mov_b64 exec, -1
    v_mov_b32 v40, 0
    v_lshlrev_b32 v1, 2, v0
    s_cmp_ge_u32 s42, 8
    s_cbranch_scc1 LA_nz
    ds_write_b32 v1, v40 offset:0
LA_nz:
    s_mul_i32 s43, s2, 102400
    v_lshl_add_u32 v19, v2, 4, s43
    s_waitcnt lgkmcnt(0)
    s_barrier
    s_mov_b64 exec, s[40:41]
    buffer_load_dwordx4 v[8:11], v3, s[8:11], 0 offen nt
    buffer_load_dwordx4 v[12:15], v18, s[12:15], 0 offen nt
    buffer_load_dwordx2 v[16:17], v18, s[12:15], 0 offen offset:16 nt
    s_mov_b64 exec, -1
    s_add_u32 s47, s42, 0
    s_min_u32 s47, s47, 99
    s_lshl_b32 s47, s47, 10
    s_add_u32 m0, s47, 40448
    v_add_u32 v41, s47, v19
    buffer_load_dwordx4 v41, s[16:19], 0 offen nt lds
    s_add_u32 s47, s42, 13
    s_min_u32 s47, s47, 99
    s_lshl_b32 s47, s47, 10
    s_add_u32 m0, s47, 40448
    v_add_u32 v41, s47, v19
    buffer_load_dwordx4 v41, s[16:19], 0 offen nt lds
    s_mov_b32 s43, 43980466
    s_movk_i32 s44, 3125
    v_mov_b32 v40, 1
    s_mov_b64 exec, s[40:41]
    s_waitcnt vmcnt(5)
    v_mul_hi_u32 v20, s43, v4
    v_mad_u32_u24 v32, v20, s44, 31
    v_lshlrev_b32 v20, 2, v20
    v_lshrrev_b32 v32, 5, v32
    ds_add_rtn_u32 v24, v20, v40 offset:0
    v_sub_u32 v28, v4, v32
    v_mul_hi_u32 v21, s43, v5
    v_mad_u32_u24 v32, v21, s44, 31
    v_lshlrev_b32 v21, 2, v21
    v_lshrrev_b32 v32, 5, v32
    ds_add_rtn_u32 v25, v21, v40 offset:0
    v_sub_u32 v29, v5, v32
    v_mul_hi_u32 v22, s43, v6
    v_mad_u32_u24 v32, v22, s44, 31
    v_lshlrev_b32 v22, 2, v22
    v_lshrrev_b32 v32, 5, v32
    ds_add_rtn_u32 v26, v22, v40 offset:0
    v_sub_u32 v30, v6, v32
    v_mul_hi_u32 v23, s43, v7
    v_mad_u32_u24 v32, v23, s44, 31
    v_lshlrev_b32 v23, 2, v23
    v_lshrrev_b32 v32, 5, v32
    ds_add_rtn_u32 v27, v23, v40 offset:0
    v_sub_u32 v31, v7, v32
    s_mov_b64 exec, -1
    s_add_u32 s47, s42, 26
    s_min_u32 s47, s47, 99
    s_lshl_b32 s47, s47, 10
    s_add_u32 m0, s47, 40448
    v_add_u32 v41, s47, v19
    buffer_load_dwordx4 v41, s[16:19], 0 offen nt lds
    s_add_u32 s47, s42, 39
    s_min_u32 s47, s47, 99
    s_lshl_b32 s47, s47, 10
    s_add_u32 m0, s47, 40448
    v_add_u32 v41, s47, v19
    buffer_load_dwordx4 v41, s[16:19], 0 offen nt lds
    s_waitcnt lgkmcnt(0)
    s_barrier
    s_cmp_lg_u32 s42, 0
    s_cbranch_scc1 LA_noscan
    v_lshlrev_b32 v1, 5, v0
    ds_read_b128 v[44:47], v1 offset:0
    ds_read_b128 v[48:51], v1 offset:16
    s_waitcnt lgkmcnt(0)
    v_add3_u32 v43, v44, v45, v46
    v_add3_u32 v43, v43, v47, v48
    v_add3_u32 v43, v43, v49, v50
    v_add_u32 v43, v43, v51
    v_mov_b32 v52, v43
    s_nop 1
    v_add_u32_dpp v52, v52, v52 row_shr:1 row_mask:0xf bank_mask:0xf bound_ctrl:0
    s_nop 1
    v_add_u32_dpp v52, v52, v52 row_shr:2 row_mask:0xf bank_mask:0xf bound_ctrl:0
    s_nop 1
    v_add_u32_dpp v52, v52, v52 row_shr:4 row_mask:0xf bank_mask:0xf bound_ctrl:0
    s_nop 1
    v_add_u32_dpp v52, v52, v52 row_shr:8 row_mask:0xf bank_mask:0xf bound_ctrl:0
    s_nop 1
    v_add_u32_dpp v52, v52, v52 row_bcast:15 row_mask:0xa bank_mask:0xf
    s_nop 1
    v_add_u32_dpp v52, v52, v52 row_bcast:31 row_mask:0xc bank_mask:0xf
    v_sub_u32 v52, v52, v43
    v_add_u32 v53, v52, v44
    v_add_u32 v54, v53, v45
    v_add_u32 v55, v54, v46
    v_add_u32 v56, v55, v47
    v_add_u32 v57, v56, v48
    v_add_u32 v58, v57, v49
    v_add_u32 v59, v58, v50
    v_lshl_or_b32 v44, v44, 16, v52
    v_lshl_or_b32 v45, v45, 16, v53
    v_lshl_or_b32 v46, v46, 16, v54
    v_lshl_or_b32 v47, v47, 16, v55
    v_lshl_or_b32 v48, v48, 16, v56
    v_lshl_or_b32 v49, v49, 16, v57
    v_lshl_or_b32 v50, v50, 16, v58
    v_lshl_or_b32 v51, v51, 16, v59
    ds_write_b128 v1, v[44:47] offset:0
    ds_write_b128 v1, v[48:51] offset:16
    s_waitcnt lgkmcnt(0)
LA_noscan:
    s_barrier
    s_mov_b64 exec, s[40:41]
    ds_read_b32 v32, v20 offset:0
    ds_read_b32 v33, v21 offset:0
    ds_read_b32 v34, v22 offset:0
    ds_read_b32 v35, v23 offset:0
    s_mov_b32 s45, 0x05040100
    s_movk_i32 s43, 10737
    v_lshlrev_b32 v3, 2, v0
    s_waitcnt vmcnt(4)
    v_mov_b32 v44, v12
    v_perm_b32 v45, v8, v13, s45
    v_alignbit_b32 v46, v14, v13, 16
    v_alignbit_b32 v47, v9, v14, 16
    v_mov_b32 v48, v15
    v_perm_b32 v49, v10, v16, s45
    v_alignbit_b32 v50, v17, v16, 16
    v_alignbit_b32 v51, v11, v17, 16
    v_mul_u32_u24 v8, s43, v8
    v_lshrrev_b32 v8, 26, v8
    v_lshl_add_u32 v28, v28, 3, v8
    v_lshlrev_b32 v28, 2, v28
    v_add_u32 v8, 0, v3
    v_mul_u32_u24 v9, s43, v9
    v_lshrrev_b32 v9, 26, v9
    v_lshl_add_u32 v29, v29, 3, v9
    v_lshlrev_b32 v29, 2, v29
    v_add_u32 v9, 1, v3
    v_mul_u32_u24 v10, s43, v10
    v_lshrrev_b32 v10, 26, v10
    v_lshl_add_u32 v30, v30, 3, v10
    v_lshlrev_b32 v30, 2, v30
    v_add_u32 v10, 2, v3
    v_mul_u32_u24 v11, s43, v11
    v_lshrrev_b32 v11, 26, v11
    v_lshl_add_u32 v31, v31, 3, v11
    v_lshlrev_b32 v31, 2, v31
    v_add_u32 v11, 3, v3
    s_waitcnt lgkmcnt(0)
    v_and_b32 v32, 0xffff, v32
    v_add_lshl_u32 v32, v32, v24, 1
    v_lshlrev_b32 v24, 2, v32
    ds_write_b64 v24, v[44:45] offset:2048
    ds_write_b16 v32, v28 offset:27648
    ds_write_b16 v32, v8 offset:34048
    v_and_b32 v33, 0xffff, v33
    v_add_lshl_u32 v33, v33, v25, 1
    v_lshlrev_b32 v25, 2, v33
    ds_write_b64 v25, v[46:47] offset:2048
    ds_write_b16 v33, v29 offset:27648
    ds_write_b16 v33, v9 offset:34048
    v_and_b32 v34, 0xffff, v34
    v_add_lshl_u32 v34, v34, v26, 1
    v_lshlrev_b32 v26, 2, v34
    ds_write_b64 v26, v[48:49] offset:2048
    ds_write_b16 v34, v30 offset:27648
    ds_write_b16 v34, v10 offset:34048
    v_and_b32 v35, 0xffff, v35
    v_add_lshl_u32 v35, v35, v27, 1
    v_lshlrev_b32 v27, 2, v35
    ds_write_b64 v27, v[50:51] offset:2048
    ds_write_b16 v35, v31 offset:27648
    ds_write_b16 v35, v11 offset:34048
    s_mov_b64 exec, -1
    s_lshl_b32 s43, s2, 11
    s_add_u32 s43, s43, 65536
    v_lshl_add_u32 v43, v0, 3, s43
    s_cmp_ge_u32 s42, 4
    s_cbranch_scc1 LA_notab
    ds_read2st64_b32 v[62:63], v3 offset0:0 offset1:4
    s_waitcnt lgkmcnt(0)
    buffer_store_dwordx2 v[62:63], v43, s[20:23], 0 offen
LA_notab:
    s_add_u32 s47, s42, 52
    s_min_u32 s47, s47, 99
    s_lshl_b32 s47, s47, 10
    s_add_u32 m0, s47, 40448
    v_add_u32 v41, s47, v19
    buffer_load_dwordx4 v41, s[16:19], 0 offen nt lds
    s_add_u32 s47, s42, 65
    s_min_u32 s47, s47, 99
    s_lshl_b32 s47, s47, 10
    s_add_u32 m0, s47, 40448
    v_add_u32 v41, s47, v19
    buffer_load_dwordx4 v41, s[16:19], 0 offen nt lds
    s_waitcnt lgkmcnt(0)
    s_barrier
    s_add_u32 s47, s42, 78
    s_min_u32 s47, s47, 99
    s_lshl_b32 s47, s47, 10
    s_add_u32 m0, s47, 40448
    v_add_u32 v41, s47, v19
    buffer_load_dwordx4 v41, s[16:19], 0 offen nt lds
    s_add_u32 s47, s42, 91
    s_min_u32 s47, s47, 99
    s_lshl_b32 s47, s47, 10
    s_add_u32 m0, s47, 40448
    v_add_u32 v41, s47, v19
    buffer_load_dwordx4 v41, s[16:19], 0 offen nt lds
    v_lshlrev_b32 v1, 4, v0
    v_and_b32 v16, 0x7fe, v0
    ds_read_b128 v[4:7], v1 offset:2048
    ds_read_b128 v[8:11], v1 offset:14848
    ds_read_b128 v[12:15], v1 offset:27648
    ds_read_u16 v20, v16 offset:34048
    ds_read_u16 v21, v16 offset:34848
    ds_read_u16 v22, v16 offset:35648
    ds_read_u16 v23, v16 offset:36448
    ds_read_u16 v24, v16 offset:37248
    ds_read_u16 v25, v16 offset:38048
    ds_read_u16 v26, v16 offset:38848
    ds_read_u16 v27, v16 offset:39648
    s_mul_i32 s43, s2, 25600
    s_add_u32 s43, s43, 1048576
    v_add_u32 v60, s43, v1
    v_add_u32 v61, 12800, v60
    s_mul_i32 s43, s2, 6400
    s_add_u32 s43, s43, 8388608
    v_add_u32 v42, s43, v1
    v_and_b32 v17, 1, v0
    v_lshlrev_b32 v17, 4, v17
    s_mul_i32 s43, s2, 102400
    s_add_u32 s43, s43, 16777216
    v_add_u32 v3, s43, v1
    v_cmp_gt_u32 vcc, 400, v0
    s_waitcnt lgkmcnt(0)
    v_lshl_add_u32 v20, v20, 5, v17
    v_lshl_add_u32 v21, v21, 5, v17
    v_lshl_add_u32 v22, v22, 5, v17
    v_lshl_add_u32 v23, v23, 5, v17
    v_lshl_add_u32 v24, v24, 5, v17
    v_lshl_add_u32 v25, v25, 5, v17
    v_lshl_add_u32 v26, v26, 5, v17
    v_lshl_add_u32 v27, v27, 5, v17
    s_waitcnt vmcnt(0)
    s_mov_b64 exec, s[40:41]
    buffer_store_dwordx4 v[4:7], v60, s[20:23], 0 offen sc1
    buffer_store_dwordx4 v[8:11], v61, s[20:23], 0 offen sc1
    s_cmp_ge_u32 s42, 7
    s_cbranch_scc1 LA_small
    s_mov_b64 exec, vcc
    buffer_store_dwordx4 v[12:15], v42, s[20:23], 0 offen sc1
    s_mov_b64 exec, s[40:41]
LA_small:
    s_cmp_ge_u32 s2, 8
    s_cbranch_scc1 LA_nocode
    s_cmp_ge_u32 s42, 4
    s_cbranch_scc1 LA_nocode
    s_getpc_b64 s[48:49]
LA_pc:
    s_add_u32 s48, s48, standalone__tensor_product_equiv_equiformer__graph_kernel-LA_pc
    s_addc_u32 s49, s49, 0
    v_lshlrev_b32 v18, 7, v0
    v_min_u32 v18, LB_end-standalone__tensor_product_equiv_equiformer__graph_kernel, v18
    global_load_dword v19, v18, s[48:49]
LA_nocode:
    s_barrier
    ds_read_b128 v[28:31], v20 offset:40448
    ds_read_b128 v[32:35], v21 offset:40448
    ds_read_b128 v[36:39], v22 offset:40448
    ds_read_b128 v[40:43], v23 offset:40448
    ds_read_b128 v[44:47], v24 offset:40448
    ds_read_b128 v[48:51], v25 offset:40448
    ds_read_b128 v[52:55], v26 offset:40448
    ds_read_b128 v[56:59], v27 offset:40448
    s_waitcnt lgkmcnt(7)
    buffer_store_dwordx4 v[28:31], v3, s[20:23], 0 offen sc1
    v_add_u32 v3, 12800, v3
    s_waitcnt lgkmcnt(6)
    buffer_store_dwordx4 v[32:35], v3, s[20:23], 0 offen sc1
    v_add_u32 v3, 12800, v3
    s_waitcnt lgkmcnt(5)
    buffer_store_dwordx4 v[36:39], v3, s[20:23], 0 offen sc1
    v_add_u32 v3, 12800, v3
    s_waitcnt lgkmcnt(4)
    buffer_store_dwordx4 v[40:43], v3, s[20:23], 0 offen sc1
    v_add_u32 v3, 12800, v3
    s_waitcnt lgkmcnt(3)
    buffer_store_dwordx4 v[44:47], v3, s[20:23], 0 offen sc1
    v_add_u32 v3, 12800, v3
    s_waitcnt lgkmcnt(2)
    buffer_store_dwordx4 v[48:51], v3, s[20:23], 0 offen sc1
    v_add_u32 v3, 12800, v3
    s_waitcnt lgkmcnt(1)
    buffer_store_dwordx4 v[52:55], v3, s[20:23], 0 offen sc1
    v_add_u32 v3, 12800, v3
    s_waitcnt lgkmcnt(0)
    buffer_store_dwordx4 v[56:59], v3, s[20:23], 0 offen sc1
    s_endpgm
LA_weights:
    s_cmp_ge_u32 s42, 10
    s_cbranch_scc1 LA_end
    v_and_b32 v3, 31, v2
    v_lshrrev_b32 v4, 5, v2
    s_cmp_gt_u32 s2, 250
    s_cbranch_scc1 LA_wsi
    s_mov_b32 s4, s32
    s_mov_b32 s5, s33
    s_mov_b32 s6, 0x2800
    s_mov_b32 s7, 0x00020000
    v_bfe_u32 v5, v3, 2, 1
    v_lshlrev_b32 v5, 4, v5
    v_lshrrev_b32 v6, 3, v3
    v_lshl_add_u32 v5, v6, 2, v5
    v_and_b32 v6, 3, v3
    v_add_u32 v5, v5, v6
    s_lshl_b32 s43, s42, 5
    v_add_u32 v5, s43, v5
    v_lshlrev_b32 v5, 1, v5
    v_mul_u32_u24 v6, 5120, v4
    v_add_u32 v5, v5, v6
    v_add_u32 v7, 2560, v5
    buffer_load_ushort v8, v5, s[4:7], 0 offen offset:0
    buffer_load_ushort v9, v5, s[4:7], 0 offen offset:640
    buffer_load_ushort v10, v5, s[4:7], 0 offen offset:1280
    buffer_load_ushort v11, v5, s[4:7], 0 offen offset:1920
    buffer_load_ushort v12, v7, s[4:7], 0 offen offset:0
    buffer_load_ushort v13, v7, s[4:7], 0 offen offset:640
    buffer_load_ushort v14, v7, s[4:7], 0 offen offset:1280
    buffer_load_ushort v15, v7, s[4:7], 0 offen offset:1920
    s_lshl_b32 s43, s42, 10
    s_add_u32 s43, s43, 0
    s_branch LA_wstore
LA_wsi:
    s_sub_u32 s43, s2, 251
    s_mul_i32 s43, s43, 10
    s_add_u32 s43, s43, s42
    s_cmp_ge_u32 s43, 20
    s_cselect_b32 s47, 1, 0
    s_mul_i32 s48, s47, 20
    s_sub_u32 s48, s43, s48
    s_lshr_b32 s49, s48, 2
    s_cmp_ge_u32 s49, 2
    s_cselect_b32 s4, s36, s34
    s_cselect_b32 s5, s37, s35
    s_cselect_b32 s50, 3, 2
    s_cselect_b32 s51, 2, 0
    s_lshl_b32 s6, s50, 13
    s_mov_b32 s7, 0x00020000
    s_sub_u32 s49, s49, s51
    s_lshl_b32 s49, s49, 6
    s_lshl_b32 s50, s47, 5
    s_add_u32 s49, s49, s50
    s_lshl_b32 s49, s49, 7
    s_and_b32 s50, s48, 1
    s_lshl_b32 s50, s50, 1
    s_add_u32 s49, s49, s50
    s_and_b32 s50, s48, 2
    s_lshl_b32 s50, s50, 5
    s_add_u32 s49, s49, s50
    v_and_b32 v3, 15, v2
    v_lshrrev_b32 v4, 4, v2
    v_lshlrev_b32 v5, 2, v3
    v_lshl_add_u32 v5, v4, 10, v5
    v_add_u32 v5, s49, v5
    buffer_load_ushort v8, v5, s[4:7], 0 offen offset:0
    buffer_load_ushort v9, v5, s[4:7], 0 offen offset:128
    buffer_load_ushort v10, v5, s[4:7], 0 offen offset:256
    buffer_load_ushort v11, v5, s[4:7], 0 offen offset:384
    buffer_load_ushort v12, v5, s[4:7], 0 offen offset:512
    buffer_load_ushort v13, v5, s[4:7], 0 offen offset:640
    buffer_load_ushort v14, v5, s[4:7], 0 offen offset:768
    buffer_load_ushort v15, v5, s[4:7], 0 offen offset:896
    s_lshl_b32 s43, s43, 10
    s_add_u32 s43, s43, 16384
LA_wstore:
    v_lshl_add_u32 v6, v2, 4, s43
    s_waitcnt vmcnt(0)
    v_lshl_or_b32 v16, v9, 16, v8
    v_lshl_or_b32 v17, v11, 16, v10
    v_lshl_or_b32 v18, v13, 16, v12
    v_lshl_or_b32 v19, v15, 16, v14
    buffer_store_dwordx4 v[16:19], v6, s[20:23], 0 offen
LA_end:
    s_endpgm
.p2align 8
.type standalone__tensor_product_equiv_equiformer__graph_kernel,@function
standalone__tensor_product_equiv_equiformer__graph_kernel:
    s_cmp_ge_u32 s2, 256
    s_cbranch_scc1 LB_end
    s_load_dwordx2 s[28:29], s[0:1], 0
    s_load_dwordx2 s[30:31], s[0:1], 72
    s_load_dwordx2 s[12:13], s[0:1], 88
    v_lshrrev_b32 v241, 6, v0
    v_and_b32 v1, 63, v0
    v_readfirstlane_b32 s72, v241
    s_and_b32 s3, s2, 7
    s_lshl_b32 s3, s3, 5
    s_lshr_b32 s96, s2, 3
    s_add_u32 s3, s3, s96
    s_and_b32 s73, s72, 1
    s_lshr_b32 s75, s72, 2
    s_lshr_b32 s74, s72, 1
    s_xor_b32 s74, s74, s75
    s_lshl_b32 s78, s75, 8
    s_add_u32 s78, s78, s3
    s_mul_i32 s79, s75, 9856
    s_mov_b64 s[60:61], 0
    s_movk_i32 s64, 320
    s_movk_i32 s65, 320
    s_mov_b64 s[66:67], -1
    s_mov_b64 s[68:69], -1
    s_mov_b32 s95, 0xffff0000
    s_mul_i32 s93, s72, 6144
    s_lshl_b32 s85, s73, 6
    s_add_u32 s86, s85, 128
    s_add_u32 s87, s85, 256
    s_add_u32 s88, s85, 384
    s_sub_u32 s77, s72, s75
    s_and_b32 s77, s77, 3
    s_mov_b32 s15, 0x00020000
    s_mul_i32 s96, s72, 2560
    s_add_u32 s96, s96, 20480
    v_lshl_add_u32 v61, v1, 4, s96
    v_mov_b32 v2, 0xfffff
    v_mov_b32 v3, 0xfffff
    v_mov_b32 v4, 0xfffff
    v_mov_b32 v5, 0xfffff
    ds_write_b128 v61, v[2:5] offset:0
    ds_write_b128 v61, v[2:5] offset:1024
    ds_write_b128 v61, v[2:5] offset:1536
    v_mov_b64 v[72:73], 0
    v_mov_b64 v[74:75], 0
    v_and_b32 v60, 0xff, v0
    v_cmp_gt_u32 vcc, 34, v60
    v_lshl_add_u32 v60, v60, 4, s79
    ds_write_b128 v60, v[72:75]
    s_mov_b64 exec, vcc
    ds_write_b128 v60, v[72:75] offset:4096
    s_mov_b64 exec, -1
    s_and_b32 s3, s78, 255
    s_lshl_b32 s3, s3, 3
    s_lshl_b32 s97, s72, 11
    s_add_u32 s3, s3, s97
    s_add_u32 s3, s3, 65536
    v_lshl_add_u32 v59, v1, 14, s3
    s_mov_b32 s14, 577536
    s_waitcnt lgkmcnt(0)
    buffer_load_dwordx2 v[50:51], v59, s[12:15], 0 offen
    s_mov_b32 s14, 0x10000000
    s_sub_u32 s4, s28, 1024
    s_subb_u32 s5, s29, 0
    s_or_b32 s5, s5, 0x02000000
    s_mov_b32 s6, 50000
    s_mov_b32 s7, 0x00020000
    s_mov_b32 s16, s30
    s_mov_b32 s17, s31
    s_mov_b32 s18, 0x186a000
    s_mov_b32 s19, 0x00020000
    s_add_u32 s8, s12, 0x1000000
    s_addc_u32 s9, s13, 0
    s_or_b32 s9, s9, 0x200000
    s_mov_b32 s10, 800000
    s_mov_b32 s11, 0x00020000
    s_add_u32 s20, s12, 0x100000
    s_addc_u32 s21, s13, 0
    s_or_b32 s21, s21, 0x80000
    s_mov_b32 s22, 800000
    s_mov_b32 s23, 0x00020000
LB_job:
    s_add_u32 s24, s12, 0x800000
    s_addc_u32 s25, s13, 0
    s_or_b32 s25, s25, 0x20000
    s_mov_b32 s26, 800000
    s_mov_b32 s27, 0x00020000
    s_lshl_b32 s3, s73, 10
    s_add_u32 s3, s3, 0
    v_lshl_add_u32 v243, v1, 4, s3
    buffer_load_dwordx4 v[206:209], v243, s[12:15], 0 offen
    buffer_load_dwordx4 v[210:213], v243, s[12:15], 0 offen offset:2048
    v_add_u32 v243, 4096, v243
    buffer_load_dwordx4 v[214:217], v243, s[12:15], 0 offen
    buffer_load_dwordx4 v[218:221], v243, s[12:15], 0 offen offset:2048
    v_add_u32 v243, 4096, v243
    buffer_load_dwordx4 v[222:225], v243, s[12:15], 0 offen
    v_cmp_lt_u32 vcc, 31, v1
    v_mov_b32 v56, s60
    v_mov_b32 v59, s61
    v_cndmask_b32 v56, v56, v59, vcc
    v_mov_b32 v57, s64
    v_mov_b32 v59, s65
    v_cndmask_b32 v57, v57, v59, vcc
    v_lshrrev_b32 v59, 5, v1
    v_mul_u32_u24 v58, 1280, v59
    v_add3_u32 v58, s96, v58, -4
    v_add_u32 v62, 64, v1
    v_add_u32 v63, 128, v1
    v_add_u32 v64, 192, v1
    v_add_u32 v65, 256, v1
    v_and_b32 v54, 31, v1
    v_lshl_add_u32 v54, v54, 3, s72
    v_mul_u32_u24 v54, 3200, v54
    v_mov_b32 v55, 1
    v_mov_b32 v252, -1
    v_mov_b32 v14, 0xfffff
    v_lshlrev_b32 v66, 4, v0
    v_add_u32 v66, 49152, v66
    ds_write_b128 v66, v[72:75] offset:0
    ds_write_b128 v66, v[72:75] offset:8192
    ds_write_b128 v66, v[72:75] offset:16384
    ds_write_b128 v66, v[72:75] offset:24576
    s_waitcnt vmcnt(5)
    v_permlane32_swap_b32 v50, v51
    v_lshrrev_b32 v53, 16, v50
    v_lshrrev_b32 v52, 16, v50
    v_and_b32 v50, 0xffff, v50
    v_add_u32_dpp v53, v53, v53 row_shr:1 row_mask:0xf bank_mask:0xf bound_ctrl:0
    s_nop 1
    v_add_u32_dpp v53, v53, v53 row_shr:2 row_mask:0xf bank_mask:0xf bound_ctrl:0
    s_nop 1
    v_add_u32_dpp v53, v53, v53 row_shr:4 row_mask:0xf bank_mask:0xf bound_ctrl:0
    s_nop 1
    v_add_u32_dpp v53, v53, v53 row_shr:8 row_mask:0xf bank_mask:0xf bound_ctrl:0
    s_nop 1
    v_add_u32_dpp v53, v53, v53 row_bcast:15 row_mask:0xa bank_mask:0xf
    v_add_u32 v54, v54, v50
    v_readlane_b32 s58, v53, 31
    v_readlane_b32 s59, v53, 63
    v_sub_u32 v53, v53, v52
    v_sub_u32 v53, v53, v56
    v_sub_u32 v59, 0, v53
    v_max_i32 v59, 0, v59
    v_sub_u32 v60, v57, v53
    v_min_i32 v60, v60, v52
    v_sub_u32 v60, v60, v59
    v_sub_u32 v54, v54, v53
    v_add_u32 v59, v59, v53
    v_lshl_add_u32 v59, v59, 2, v58
    v_lshl_add_u32 v61, v60, 2, v59
    v_cmpx_lt_i32 vcc, 0, v60
    ds_write_b32 v61, v54
LB_pl:
    v_cmpx_lt_i32 vcc, 1, v60
    ds_write2_b32 v59, v54, v54 offset0:1 offset1:2
    v_cmpx_lt_i32 vcc, 3, v60
    ds_write2_b32 v59, v54, v54 offset0:3 offset1:4
    v_cmpx_lt_i32 vcc, 5, v60
    ds_write2_b32 v59, v54, v54 offset0:5 offset1:6
    v_cmpx_lt_i32 vcc, 7, v60
    ds_write2_b32 v59, v54, v54 offset0:7 offset1:8
    v_add_u32 v59, 32, v59
    v_subrev_u32 v60, 8, v60
    s_cbranch_execnz LB_pl
    s_mov_b64 exec, -1
    v_lshl_add_u32 v58, v1, 2, s96
    ds_read_b32 v10, v58 offset:0
    ds_read_b32 v11, v58 offset:256
    ds_read_b32 v12, v58 offset:512
    ds_read_b32 v13, v58 offset:768
    ds_read_b32 v15, v58 offset:1280
    ds_read_b32 v16, v58 offset:1536
    ds_read_b32 v17, v58 offset:1792
    ds_read_b32 v18, v58 offset:2048
    s_waitcnt lgkmcnt(7)
    v_add_u32 v10, v10, v1
    buffer_load_ushort v20, v10, s[24:27], 0 idxen
    s_waitcnt lgkmcnt(6)
    v_add_u32 v11, v11, v62
    buffer_load_ushort v21, v11, s[24:27], 0 idxen
    s_waitcnt lgkmcnt(5)
    v_add_u32 v12, v12, v63
    buffer_load_ushort v22, v12, s[24:27], 0 idxen
    s_waitcnt lgkmcnt(4)
    v_add_u32 v13, v13, v64
    buffer_load_ushort v23, v13, s[24:27], 0 idxen
    s_waitcnt lgkmcnt(3)
    v_add_u32 v15, v15, v1
    buffer_load_ushort v25, v15, s[24:27], 0 idxen
    s_waitcnt lgkmcnt(2)
    v_add_u32 v16, v16, v62
    buffer_load_ushort v26, v16, s[24:27], 0 idxen
    s_waitcnt lgkmcnt(1)
    v_add_u32 v17, v17, v63
    buffer_load_ushort v27, v17, s[24:27], 0 idxen
    s_waitcnt lgkmcnt(0)
    v_add_u32 v18, v18, v64
    buffer_load_ushort v28, v18, s[24:27], 0 idxen
    s_barrier
    buffer_load_dwordx2 v[2:3], v10, s[20:23], 0 idxen
    buffer_load_dwordx2 v[4:5], v11, s[20:23], 0 idxen
    buffer_load_dwordx2 v[6:7], v12, s[20:23], 0 idxen
    buffer_load_dwordx2 v[8:9], v13, s[20:23], 0 idxen
    v_lshlrev_b32 v66, 4, v0
    v_add_u32 v66, 49152, v66
    ds_write_b128 v66, v[72:75] offset:32768
    ds_write_b128 v66, v[72:75] offset:40960
    ds_write_b128 v66, v[72:75] offset:49152
    v_min_u32 v66, 55280, v66
    ds_write_b128 v66, v[72:75] offset:57344
    v_mov_b32 v76, 0xc4000000
    v_mov_b32 v77, 0xc4000000
    v_mov_b32 v78, 0xc4000000
    v_mov_b32 v79, 0xc4000000
    v_lshlrev_b32 v66, 4, v0
    v_add_u32 v66, 112640, v66
    ds_write_b128 v66, v[76:79] offset:0
    ds_write_b128 v66, v[76:79] offset:8192
    s_sub_u32 s70, s58, s60
    s_min_u32 s62, s70, s64
    s_sub_u32 s70, s70, s62
    s_sub_u32 s71, s59, s61
    s_min_u32 s63, s71, s65
    s_sub_u32 s71, s71, s63
    v_cmp_gt_u32 s[36:37], s26, v10
    v_cmp_gt_u32 s[38:39], s26, v11
    v_cmp_gt_u32 s[40:41], s26, v12
    v_cmp_gt_u32 s[42:43], s26, v13
    v_cmp_gt_u32 s[46:47], s26, v15
    v_cmp_gt_u32 s[48:49], s26, v16
    v_cmp_gt_u32 s[50:51], s26, v17
    v_cmp_gt_u32 s[52:53], s26, v18
    s_max_u32 s76, s62, s63
    s_lshl_b32 s3, s73, 4
    v_and_b32 v241, 31, v1
    v_xor_b32 v241, s3, v241
    v_lshrrev_b32 v242, 5, v1
    v_and_b32 v243, 1, v241
    v_lshrrev_b32 v229, 1, v241
    v_lshl_add_u32 v229, v243, 4, v229
    v_xor_b32 v227, v243, v242
    v_lshlrev_b32 v227, 4, v227
    v_lshl_add_u32 v227, v229, 5, v227
    v_lshlrev_b32 v229, 3, v229
    v_bfe_u32 v243, v241, 3, 1
    v_xor_b32 v243, v243, v242
    v_lshlrev_b32 v243, 1, v243
    v_and_b32 v237, 1, v241
    v_or_b32 v243, v243, v237
    v_lshlrev_b32 v243, 4, v243
    v_lshl_add_u32 v243, v237, 10, v243
    v_lshrrev_b32 v236, 1, v241
    v_lshl_add_u32 v236, v236, 6, v243
    v_add_u32 v236, s93, v236
    v_xor_b32 v237, 16, v236
    v_lshrrev_b32 v241, 2, v1
    v_lshlrev_b32 v231, 3, v241
    v_bfe_u32 v241, v1, 4, 1
    v_lshlrev_b32 v241, 1, v241
    v_and_b32 v242, 3, v1
    v_xor_b32 v241, v241, v242
    v_lshlrev_b32 v233, 4, v241
    v_xor_b32 v235, 16, v233
    v_add_u32 v233, 1024, v233
    s_waitcnt vmcnt(11)
    s_mov_b64 exec, s[36:37]
    ds_add_rtn_u32 v30, v20, v55 offset:0
    s_waitcnt vmcnt(10)
    s_mov_b64 exec, s[38:39]
    ds_add_rtn_u32 v31, v21, v55 offset:0
    s_waitcnt vmcnt(9)
    s_mov_b64 exec, s[40:41]
    ds_add_rtn_u32 v32, v22, v55 offset:0
    s_waitcnt vmcnt(8)
    s_mov_b64 exec, s[42:43]
    ds_add_rtn_u32 v33, v23, v55 offset:0
    s_waitcnt vmcnt(7)
    s_mov_b64 exec, s[46:47]
    ds_add_rtn_u32 v35, v25, v55 offset:9856
    s_waitcnt vmcnt(6)
    s_mov_b64 exec, s[48:49]
    ds_add_rtn_u32 v36, v26, v55 offset:9856
    s_waitcnt vmcnt(5)
    s_mov_b64 exec, s[50:51]
    ds_add_rtn_u32 v37, v27, v55 offset:9856
    s_waitcnt vmcnt(4)
    s_mov_b64 exec, s[52:53]
    ds_add_rtn_u32 v38, v28, v55 offset:9856
    s_mov_b64 exec, -1
    s_cmpk_gt_u32 s76, 256
    s_cbranch_scc1 L_rare_1
L_rback_2:
    s_or_b32 s3, s70, s71
    s_cbranch_scc1 LB_more
LB_more_back:
    s_cmp_lg_u32 s77, 0
    s_cbranch_scc1 LB_alate
    buffer_load_dwordx4 v[90:93], v10, s[8:11], 0 idxen
    buffer_load_dwordx4 v[94:97], v10, s[8:11], 0 idxen offset:16
    buffer_load_dwordx4 v[98:101], v11, s[8:11], 0 idxen
    buffer_load_dwordx4 v[102:105], v11, s[8:11], 0 idxen offset:16
    buffer_load_dwordx4 v[106:109], v12, s[8:11], 0 idxen
    buffer_load_dwordx4 v[110:113], v12, s[8:11], 0 idxen offset:16
    buffer_load_dwordx4 v[114:117], v13, s[8:11], 0 idxen
    buffer_load_dwordx4 v[118:121], v13, s[8:11], 0 idxen offset:16
    s_setprio 2
    s_mul_i32 s96, s78, 3125
    s_add_u32 s97, s96, 3156
    s_add_u32 s96, s96, 31
    s_lshr_b32 s96, s96, 5
    s_lshr_b32 s97, s97, 5
    s_sub_u32 s97, s97, s96
    s_sub_u32 s98, 128, s97
    s_sub_u32 s97, s97, 64
LB_alate:
    v_lshrrev_b32 v40, 3, v20
    v_and_b32 v40, 0x1fc, v40
    v_lshrrev_b32 v41, 3, v21
    v_and_b32 v41, 0x1fc, v41
    v_lshrrev_b32 v42, 3, v22
    v_and_b32 v42, 0x1fc, v42
    v_lshrrev_b32 v43, 3, v23
    v_and_b32 v43, 0x1fc, v43
    v_lshrrev_b32 v45, 3, v25
    v_and_b32 v45, 0x1fc, v45
    v_lshrrev_b32 v46, 3, v26
    v_and_b32 v46, 0x1fc, v46
    v_lshrrev_b32 v47, 3, v27
    v_and_b32 v47, 0x1fc, v47
    v_lshrrev_b32 v48, 3, v28
    v_and_b32 v48, 0x1fc, v48
    s_waitcnt lgkmcnt(0)
    s_barrier
    s_cmp_lg_u32 s77, 0
    s_cbranch_scc1 LB_idle
    v_lshl_add_u32 v65, v1, 2, s79
    v_lshl_add_u32 v66, v1, 5, s79
    ds_read_b128 v[130:133], v66 offset:0
    ds_read_b128 v[134:137], v66 offset:16
    ds_read_b128 v[138:141], v66 offset:2048
    ds_read_b128 v[142:145], v66 offset:2064
    v_cmp_gt_u32 s[56:57], s97, v1
    s_waitcnt lgkmcnt(2)
    v_add3_u32 v59, v130, v131, v132
    v_add3_u32 v59, v59, v133, v134
    v_add3_u32 v59, v59, v135, v136
    v_add_u32 v59, v59, v137
    s_waitcnt lgkmcnt(0)
    v_add3_u32 v60, v138, v139, v140
    v_add3_u32 v60, v60, v141, v142
    v_add3_u32 v60, v60, v143, v144
    v_add_u32 v60, v60, v145
    v_min_u32 v61, 63, v59
    v_sub_u32 v61, 63, v61
    v_lshlrev_b32 v61, 2, v61
    v_min_u32 v62, 63, v60
    v_sub_u32 v62, 63, v62
    v_lshlrev_b32 v62, 2, v62
    v_add_u32 v66, s79, v61
    v_add_u32 v67, s79, v62
    ds_add_rtn_u32 v63, v66, v55 offset:4096
    s_mov_b64 exec, s[56:57]
    ds_add_rtn_u32 v64, v67, v55 offset:4096
    s_mov_b64 exec, -1
    ds_read_b32 v66, v65 offset:4096
    v_lshl_or_b32 v59, v59, 8, v1
    v_lshl_or_b32 v60, v60, 8, v1
    v_or_b32 v60, 64, v60
    s_waitcnt lgkmcnt(0)
    v_mov_b32 v67, v66
    s_nop 1
    v_add_u32_dpp v67, v67, v67 row_shr:1 row_mask:0xf bank_mask:0xf bound_ctrl:0
    s_nop 1
    v_add_u32_dpp v67, v67, v67 row_shr:2 row_mask:0xf bank_mask:0xf bound_ctrl:0
    s_nop 1
    v_add_u32_dpp v67, v67, v67 row_shr:4 row_mask:0xf bank_mask:0xf bound_ctrl:0
    s_nop 1
    v_add_u32_dpp v67, v67, v67 row_shr:8 row_mask:0xf bank_mask:0xf bound_ctrl:0
    s_nop 1
    v_add_u32_dpp v67, v67, v67 row_bcast:15 row_mask:0xa bank_mask:0xf
    s_nop 1
    v_add_u32_dpp v67, v67, v67 row_bcast:31 row_mask:0xc bank_mask:0xf
    v_sub_u32 v67, v67, v66
    ds_bpermute_b32 v61, v61, v67
    ds_bpermute_b32 v62, v62, v67
    v_cmp_gt_u32 vcc, s98, v1
    v_lshlrev_b32 v69, 1, v1
    v_subrev_u32 v69, s98, v69
    v_cndmask_b32 v69, v69, v1, vcc
    v_cndmask_b32 v70, 2, v55, vcc
    v_lshl_add_u32 v69, v69, 2, s79
    v_add_u32 v69, 4672, v69
    s_waitcnt lgkmcnt(0)
    v_add_u32 v61, v61, v63
    v_add_u32 v62, v62, v64
    v_lshl_add_u32 v61, v61, 2, s79
    v_lshl_add_u32 v62, v62, 2, s79
    ds_write_b32 v61, v59 offset:4672
    s_mov_b64 exec, s[56:57]
    ds_write_b32 v62, v60 offset:4672
    s_mov_b64 exec, -1
    ds_read2_b32 v[72:73], v69 offset0:0 offset1:1
    s_barrier
    s_waitcnt lgkmcnt(0)
    v_lshrrev_b32 v80, 8, v72
    v_lshrrev_b32 v81, 8, v73
    v_lshrrev_b32 v60, 1, v80
    v_sub_u32 v59, v80, v60
    v_cndmask_b32 v80, v80, v59, vcc
    v_cndmask_b32 v81, v81, v60, vcc
    v_max_u32 v68, v80, v81
    v_min_u32 v61, 63, v68
    v_sub_u32 v61, 63, v61
    v_lshlrev_b32 v61, 2, v61
    v_add_u32 v66, s79, v61
    ds_add_rtn_u32 v63, v66, v55 offset:4352
    ds_read_b32 v66, v65 offset:4352
    v_lshrrev_b32 v130, 8, v72
    v_and_b32 v72, 0xff, v72
    v_lshl_add_u32 v132, v72, 2, s79
    ds_read_b32 v132, v132 offset:5248
    v_lshrrev_b32 v131, 8, v73
    v_and_b32 v73, 0xff, v73
    v_lshl_add_u32 v133, v73, 2, s79
    ds_read_b32 v133, v133 offset:5248
    s_waitcnt lgkmcnt(0)
    v_mov_b32 v67, v66
    s_nop 1
    v_add_u32_dpp v67, v67, v67 row_shr:1 row_mask:0xf bank_mask:0xf bound_ctrl:0
    s_nop 1
    v_add_u32_dpp v67, v67, v67 row_shr:2 row_mask:0xf bank_mask:0xf bound_ctrl:0
    s_nop 1
    v_add_u32_dpp v67, v67, v67 row_shr:4 row_mask:0xf bank_mask:0xf bound_ctrl:0
    s_nop 1
    v_add_u32_dpp v67, v67, v67 row_shr:8 row_mask:0xf bank_mask:0xf bound_ctrl:0
    s_nop 1
    v_add_u32_dpp v67, v67, v67 row_bcast:15 row_mask:0xa bank_mask:0xf
    s_nop 1
    v_add_u32_dpp v67, v67, v67 row_bcast:31 row_mask:0xc bank_mask:0xf
    v_sub_u32 v67, v67, v66
    ds_bpermute_b32 v61, v61, v67
    s_waitcnt lgkmcnt(0)
    v_add_u32 v61, v61, v63
    v_lshrrev_b32 v62, 4, v61
    v_lshl_add_u32 v66, v62, 2, s79
    v_max_u32 v68, 3, v68
    ds_max_u32 v66, v68 offset:4608
    v_mov_b32 v67, s79
    ds_read_b128 v[76:79], v67 offset:4608
    ds_read_b32 v68, v66 offset:4608
    v_add_u32 v74, s96, v72
    v_add_u32 v75, s96, v73
    v_lshlrev_b32 v74, 9, v74
    v_lshlrev_b32 v75, 9, v75
    v_mov_b32 v60, 0x7f000000
    v_cndmask_b32 v75, v75, v60, vcc
    s_lshl_b32 s3, s75, 9
    s_add_u32 s3, s3, 128512
    v_lshl_add_u32 v66, v61, 3, s3
    ds_write_b64 v66, v[74:75]
    s_waitcnt lgkmcnt(1)
    v_mov_b32 v64, 0
    v_cmp_lt_u32 s[56:57], 0, v62
    v_add_u32 v59, v64, v76
    s_nop 0
    v_cndmask_b32 v64, v64, v59, s[56:57]
    v_cmp_lt_u32 s[56:57], 1, v62
    v_add_u32 v59, v64, v77
    s_nop 0
    v_cndmask_b32 v64, v64, v59, s[56:57]
    v_cmp_lt_u32 s[56:57], 2, v62
    v_add_u32 v59, v64, v78
    s_nop 0
    v_cndmask_b32 v64, v64, v59, s[56:57]
    v_and_b32 v61, 15, v61
    v_lshl_add_u32 v61, v64, 5, v61
    v_and_b32 v61, 0x7ff, v61
    v_lshl_or_b32 v59, v70, 30, v61
    v_add_u32 v60, 16, v59
    v_and_b32 v70, 1, v70
    v_lshlrev_b32 v154, v70, v68
    v_sub_u32 v134, v154, v130
    v_sub_u32 v135, v68, v131
    v_lshl_or_b32 v59, v132, 11, v59
    v_lshl_or_b32 v60, v133, 11, v60
    v_lshl_or_b32 v59, v134, 18, v59
    v_lshl_or_b32 v60, v135, 18, v60
    v_lshl_add_u32 v72, v72, 2, s79
    v_lshl_add_u32 v73, v73, 2, s79
    ds_write_b32 v72, v59 offset:5248
    s_not_b64 exec, vcc
    ds_write_b32 v73, v60 offset:5248
    s_mov_b64 exec, -1
    v_add_u32 v134, v134, v132
    v_add_u32 v135, v135, v133
    v_cndmask_b32 v133, v133, v132, vcc
    v_cndmask_b32 v135, v135, v134, vcc
    v_add_u32 v132, v132, v70
    v_add_u32 v134, v134, v70
    v_lshrrev_b32 v132, v70, v132
    v_lshrrev_b32 v133, v70, v133
    v_lshrrev_b32 v134, v70, v134
    v_lshrrev_b32 v135, v70, v135
    v_add_lshl_u32 v134, v134, v64, 16
    v_add_lshl_u32 v135, v135, v64, 16
    v_add3_u32 v80, v132, v64, v134
    v_add3_u32 v81, v133, v64, v135
    ds_write_b64 v66, v[80:81] offset:1024
    ds_read_b32 v20, v20 offset:5760
    ds_read_b32 v21, v21 offset:5760
    ds_read_b32 v22, v22 offset:5760
    ds_read_b32 v23, v23 offset:5760
    ds_read_b32 v25, v25 offset:15616
    ds_read_b32 v26, v26 offset:15616
    ds_read_b32 v27, v27 offset:15616
    ds_read_b32 v28, v28 offset:15616
    s_setprio 0
    s_waitcnt lgkmcnt(8)
    s_branch LB_nosort
LB_idle:
    buffer_load_dwordx4 v[90:93], v10, s[8:11], 0 idxen
    buffer_load_dwordx4 v[94:97], v10, s[8:11], 0 idxen offset:16
    s_cmp_eq_u32 s77, 3
    s_cbranch_scc1 LB_nopre
    s_lshl_b32 s3, s77, 11
    s_add_u32 s3, s3, s79
    s_sub_u32 s3, s3, 2048
    v_lshl_add_u32 v66, v1, 5, s3
    ds_read_b128 v[130:133], v66 offset:0
    ds_read_b128 v[134:137], v66 offset:16
    v_mov_b32 v138, 0
    s_waitcnt lgkmcnt(0)
    v_add_u32 v139, v138, v130
    v_add_u32 v140, v139, v131
    v_add_u32 v141, v140, v132
    v_add_u32 v142, v141, v133
    v_add_u32 v143, v142, v134
    v_add_u32 v144, v143, v135
    v_add_u32 v145, v144, v136
    ds_write_b128 v66, v[138:141] offset:5760
    ds_write_b128 v66, v[142:145] offset:5776
    v_add_u32 v146, v145, v137
    v_add_u32 v147, 4, v146
    v_mad_i32_i24 v148, v147, -7, 16
    v_mul_u32_u24 v130, 12, v146
    v_mov_b32 v149, 0
    v_mov_b32 v150, 0
    v_lshl_add_u32 v151, v145, 3, v148
    v_add_u32 v149, v149, v151
    v_cmp_lt_i32 vcc, v149, v150
    v_min_i32 v150, v150, v149
    v_add_u32 v148, v148, v147
    v_cndmask_b32 v146, v146, v145, vcc
    v_lshl_add_u32 v151, v144, 3, v148
    v_add_u32 v149, v149, v151
    v_cmp_lt_i32 vcc, v149, v150
    v_min_i32 v150, v150, v149
    v_add_u32 v148, v148, v147
    v_cndmask_b32 v146, v146, v144, vcc
    v_lshl_add_u32 v151, v143, 3, v148
    v_add_u32 v149, v149, v151
    v_cmp_lt_i32 vcc, v149, v150
    v_min_i32 v150, v150, v149
    v_add_u32 v148, v148, v147
    v_cndmask_b32 v146, v146, v143, vcc
    v_lshl_add_u32 v151, v142, 3, v148
    v_add_u32 v149, v149, v151
    v_cmp_lt_i32 vcc, v149, v150
    v_min_i32 v150, v150, v149
    v_add_u32 v148, v148, v147
    v_cndmask_b32 v146, v146, v142, vcc
    v_lshl_add_u32 v151, v141, 3, v148
    v_add_u32 v149, v149, v151
    v_cmp_lt_i32 vcc, v149, v150
    v_min_i32 v150, v150, v149
    v_add_u32 v148, v148, v147
    v_cndmask_b32 v146, v146, v141, vcc
    v_lshl_add_u32 v151, v140, 3, v148
    v_add_u32 v149, v149, v151
    v_cmp_lt_i32 vcc, v149, v150
    v_min_i32 v150, v150, v149
    v_add_u32 v148, v148, v147
    v_cndmask_b32 v146, v146, v140, vcc
    v_lshl_add_u32 v151, v139, 3, v148
    v_add_u32 v149, v149, v151
    v_cmp_lt_i32 vcc, v149, v150
    v_min_i32 v150, v150, v149
    v_add_u32 v148, v148, v147
    v_cndmask_b32 v146, v146, v139, vcc
    v_lshrrev_b32 v130, 6, v130
    v_max_u32 v146, v146, v130
    s_lshl_b32 s3, s77, 8
    s_add_u32 s3, s3, s79
    v_lshl_add_u32 v66, v1, 2, s3
    ds_write_b32 v66, v146 offset:4992
LB_nopre:
    s_waitcnt lgkmcnt(0)
    s_barrier
    ds_read_b32 v20, v20 offset:5760
    ds_read_b32 v21, v21 offset:5760
    ds_read_b32 v22, v22 offset:5760
    ds_read_b32 v23, v23 offset:5760
    ds_read_b32 v25, v25 offset:15616
    ds_read_b32 v26, v26 offset:15616
    ds_read_b32 v27, v27 offset:15616
    ds_read_b32 v28, v28 offset:15616
    buffer_load_dwordx4 v[98:101], v11, s[8:11], 0 idxen
    buffer_load_dwordx4 v[102:105], v11, s[8:11], 0 idxen offset:16
    buffer_load_dwordx4 v[106:109], v12, s[8:11], 0 idxen
    buffer_load_dwordx4 v[110:113], v12, s[8:11], 0 idxen offset:16
    buffer_load_dwordx4 v[114:117], v13, s[8:11], 0 idxen
    buffer_load_dwordx4 v[118:121], v13, s[8:11], 0 idxen offset:16
LB_nosort:
    s_barrier
    ds_read_b32 v40, v40 offset:5248
    ds_read_b32 v41, v41 offset:5248
    ds_read_b32 v42, v42 offset:5248
    ds_read_b32 v43, v43 offset:5248
    v_mov_b32 v59, 0
    ds_read_b128 v[72:75], v59 offset:4608
    ds_read_b128 v[76:79], v59 offset:14464
    ds_read_b64 v[80:81], v59 offset:4624
    s_mov_b32 s3, 112640
    s_waitcnt lgkmcnt(6)
    v_add_u32 v30, v30, v20
    v_bfe_u32 v59, v40, 11, 7
    v_cmp_ge_u32 vcc, v30, v59
    v_bfe_u32 v59, v40, 18, 7
    v_lshrrev_b32 v20, 26, v40
    v_cndmask_b32 v59, 0, v59, vcc
    v_add_u32 v30, v30, v59
    v_mad_u32_u24 v40, v30, v20, v40
    v_and_b32 v40, 0x7ff, v40
    v_lshl_add_u32 v30, v40, 3, s3
    s_waitcnt lgkmcnt(5)
    v_add_u32 v31, v31, v21
    v_bfe_u32 v59, v41, 11, 7
    v_cmp_ge_u32 vcc, v31, v59
    v_bfe_u32 v59, v41, 18, 7
    v_lshrrev_b32 v21, 26, v41
    v_cndmask_b32 v59, 0, v59, vcc
    v_add_u32 v31, v31, v59
    v_mad_u32_u24 v41, v31, v21, v41
    v_and_b32 v41, 0x7ff, v41
    v_lshl_add_u32 v31, v41, 3, s3
    s_waitcnt lgkmcnt(4)
    v_add_u32 v32, v32, v22
    v_bfe_u32 v59, v42, 11, 7
    v_cmp_ge_u32 vcc, v32, v59
    v_bfe_u32 v59, v42, 18, 7
    v_lshrrev_b32 v22, 26, v42
    v_cndmask_b32 v59, 0, v59, vcc
    v_add_u32 v32, v32, v59
    v_mad_u32_u24 v42, v32, v22, v42
    v_and_b32 v42, 0x7ff, v42
    v_lshl_add_u32 v32, v42, 3, s3
    s_waitcnt lgkmcnt(3)
    v_add_u32 v33, v33, v23
    v_bfe_u32 v59, v43, 11, 7
    v_cmp_ge_u32 vcc, v33, v59
    v_bfe_u32 v59, v43, 18, 7
    v_lshrrev_b32 v23, 26, v43
    v_cndmask_b32 v59, 0, v59, vcc
    v_add_u32 v33, v33, v59
    v_mad_u32_u24 v43, v33, v23, v43
    v_and_b32 v43, 0x7ff, v43
    v_lshl_add_u32 v33, v43, 3, s3
    s_waitcnt vmcnt(8) lgkmcnt(0)
    s_mov_b64 exec, s[36:37]
    ds_write_b64 v30, v[2:3]
    s_mov_b64 exec, s[38:39]
    ds_write_b64 v31, v[4:5]
    s_mov_b64 exec, s[40:41]
    ds_write_b64 v32, v[6:7]
    s_mov_b64 exec, s[42:43]
    ds_write_b64 v33, v[8:9]
    s_mov_b64 exec, -1
    ds_read_b32 v45, v45 offset:15104
    ds_read_b32 v46, v46 offset:15104
    ds_read_b32 v47, v47 offset:15104
    ds_read_b32 v48, v48 offset:15104
    s_cmpk_gt_u32 s76, 256
    s_cbranch_scc1 L_rare_3
L_rback_4:
    v_readfirstlane_b32 s28, v72
    v_readfirstlane_b32 s29, v73
    v_readfirstlane_b32 s30, v74
    v_readfirstlane_b32 s31, v75
    v_readfirstlane_b32 s32, v76
    v_readfirstlane_b32 s33, v77
    v_readfirstlane_b32 s34, v78
    v_readfirstlane_b32 s35, v79
    v_readfirstlane_b32 s70, v80
    v_readfirstlane_b32 s71, v81
    s_add_u32 s29, s29, s28
    s_add_u32 s30, s30, s29
    s_add_u32 s31, s31, s30
    s_add_u32 s33, s33, s32
    s_add_u32 s34, s34, s33
    s_add_u32 s35, s35, s34
    s_max_u32 s3, s31, s35
    s_cmp_gt_u32 s3, 62
    s_cbranch_scc1 LB_shrink
    s_bitcmp1_b32 s74, 0
    s_cselect_b32 s3, s28, 0
    s_cselect_b32 s96, s29, s28
    s_cselect_b32 s97, s30, s29
    s_cselect_b32 s98, s31, s30
    s_bitcmp1_b32 s74, 1
    s_cselect_b32 s3, s97, s3
    s_cselect_b32 s96, s98, s96
    s_sub_u32 s92, s96, s3
    s_lshl_b32 s82, s3, 10
    s_add_u32 s82, s82, 49152
    s_lshl_b32 s81, s3, 8
    s_add_u32 s81, s81, 112640
    s_sub_u32 s83, 1, s92
    s_lshl_b32 s83, s83, 8
    s_mov_b32 s6, 50000
    v_add_u32 v240, s81, v231
    s_mov_b32 s80, 0
    s_waitcnt lgkmcnt(0)
    s_barrier
    ds_read_u16 v232, v240 offset:6
    ds_read_u16 v234, v240 offset:134
    v_add_u32 v240, 256, v240
    s_waitcnt lgkmcnt(0)
    s_add_u32 m0, s93, 0
    s_nop 0
    buffer_load_dwordx4 v[232:233], s[4:7], s86 idxen offen lds
    buffer_load_dwordx4 v[234:235], s[4:7], s86 idxen offen offset:1024 lds
    s_add_u32 m0, s93, 2048
    s_nop 0
    buffer_load_dwordx4 v[232:233], s[4:7], s87 idxen offen lds
    buffer_load_dwordx4 v[234:235], s[4:7], s87 idxen offen offset:1024 lds
    v_lshlrev_b32 v30, 5, v40
    v_and_or_b32 v30, v40, 16, v30
    v_xor_b32 v40, 16, v30
    v_lshlrev_b32 v31, 5, v41
    v_and_or_b32 v31, v41, 16, v31
    v_xor_b32 v41, 16, v31
    v_lshlrev_b32 v32, 5, v42
    v_and_or_b32 v32, v42, 16, v32
    v_xor_b32 v42, 16, v32
    v_lshlrev_b32 v33, 5, v43
    v_and_or_b32 v33, v43, 16, v33
    v_xor_b32 v43, 16, v33
    s_waitcnt vmcnt(4)
    s_mov_b64 exec, s[36:37]
    ds_write_b128 v30, v[90:93] offset:49152
    ds_write_b128 v40, v[94:97] offset:49152
    s_mov_b64 exec, s[38:39]
    ds_write_b128 v31, v[98:101] offset:49152
    ds_write_b128 v41, v[102:105] offset:49152
    s_mov_b64 exec, s[40:41]
    ds_write_b128 v32, v[106:109] offset:49152
    ds_write_b128 v42, v[110:113] offset:49152
    s_mov_b64 exec, s[42:43]
    ds_write_b128 v33, v[114:117] offset:49152
    ds_write_b128 v43, v[118:121] offset:49152
    s_mov_b64 exec, -1
    s_cmpk_gt_u32 s76, 256
    s_cbranch_scc1 L_rare_5
L_rback_6:
    s_add_u32 m0, s93, 4096
    s_nop 0
    buffer_load_dwordx4 v[232:233], s[4:7], s88 idxen offen lds
    buffer_load_dwordx4 v[234:235], s[4:7], s88 idxen offen offset:1024 lds
    ds_read_u16 v232, v240 offset:6
    ds_read_u16 v234, v240 offset:134
    v_add_u32 v35, v35, v25
    v_bfe_u32 v59, v45, 11, 7
    v_cmp_ge_u32 vcc, v35, v59
    v_bfe_u32 v59, v45, 18, 7
    v_lshrrev_b32 v25, 26, v45
    v_cndmask_b32 v59, 0, v59, vcc
    v_add_u32 v35, v35, v59
    v_mad_u32_u24 v45, v35, v25, v45
    v_and_b32 v45, 0x7ff, v45
    v_lshl_or_b32 v45, v45, 20, v15
    v_cndmask_b32 v248, -1, v45, s[46:47]
    v_add_u32 v36, v36, v26
    v_bfe_u32 v59, v46, 11, 7
    v_cmp_ge_u32 vcc, v36, v59
    v_bfe_u32 v59, v46, 18, 7
    v_lshrrev_b32 v26, 26, v46
    v_cndmask_b32 v59, 0, v59, vcc
    v_add_u32 v36, v36, v59
    v_mad_u32_u24 v46, v36, v26, v46
    v_and_b32 v46, 0x7ff, v46
    v_lshl_or_b32 v46, v46, 20, v16
    v_cndmask_b32 v249, -1, v46, s[48:49]
    v_add_u32 v37, v37, v27
    v_bfe_u32 v59, v47, 11, 7
    v_cmp_ge_u32 vcc, v37, v59
    v_bfe_u32 v59, v47, 18, 7
    v_lshrrev_b32 v27, 26, v47
    v_cndmask_b32 v59, 0, v59, vcc
    v_add_u32 v37, v37, v59
    v_mad_u32_u24 v47, v37, v27, v47
    v_and_b32 v47, 0x7ff, v47
    v_lshl_or_b32 v47, v47, 20, v17
    v_cndmask_b32 v250, -1, v47, s[50:51]
    v_add_u32 v38, v38, v28
    v_bfe_u32 v59, v48, 11, 7
    v_cmp_ge_u32 vcc, v38, v59
    v_bfe_u32 v59, v48, 18, 7
    v_lshrrev_b32 v28, 26, v48
    v_cndmask_b32 v59, 0, v59, vcc
    v_add_u32 v38, v38, v59
    v_mad_u32_u24 v48, v38, v28, v48
    v_and_b32 v48, 0x7ff, v48
    v_lshl_or_b32 v48, v48, 20, v18
    v_cndmask_b32 v251, -1, v48, s[52:53]
    s_waitcnt lgkmcnt(0)
    s_barrier
    s_waitcnt vmcnt(4)
LB_round:
    ds_read_b128 v[194:197], v236 offset:0
    ds_read_b128 v[198:201], v237 offset:0
    v_add_u32 v238, s82, v227
    v_add_u32 v239, s81, v229
    ds_read_b128 v[202:205], v238
    s_sub_u32 s91, s92, 1
    s_setprio 1
    s_mul_i32 s3, s92, 3
    s_sub_u32 s84, s3, 3
    s_sub_u32 s3, s3, 4
    s_mov_b64 s[42:43], 0
    s_mul_i32 s89, s92, 48
    s_lshr_b32 s89, s89, 5
    s_min_u32 s89, s89, s3
    s_max_u32 s89, s89, 3
    s_lshl_b64 s[42:43], s[42:43], 8
    s_or_b32 s42, s42, s89
    s_mul_i32 s89, s92, 75
    s_add_u32 s89, s89, 64
    s_lshr_b32 s89, s89, 5
    s_min_u32 s89, s89, s3
    s_max_u32 s89, s89, 3
    s_lshl_b64 s[42:43], s[42:43], 8
    s_or_b32 s42, s42, s89
    s_waitcnt lgkmcnt(0)
    v_lshlrev_b32 v178, 16, v194
    v_mfma_f32_32x32x16_bf16 v[130:145], v[218:221], v[202:205], 0
    v_and_b32 v179, s95, v194
    v_lshlrev_b32 v180, 16, v195
    v_and_b32 v181, s95, v195
    v_lshlrev_b32 v182, 16, v196
    v_and_b32 v183, s95, v196
    v_lshlrev_b32 v184, 16, v197
    v_mfma_f32_32x32x16_bf16 v[162:177], v[222:225], v[202:205], 0
    v_and_b32 v185, s95, v197
    v_lshlrev_b32 v186, 16, v198
    v_and_b32 v187, s95, v198
    v_lshlrev_b32 v188, 16, v199
    v_and_b32 v189, s95, v199
    v_lshlrev_b32 v190, 16, v200
    v_and_b32 v191, s95, v200
    v_lshlrev_b32 v192, 16, v201
    v_and_b32 v193, s95, v201
    s_add_u32 m0, s93, 0
    ds_read_u16_d16_hi v226, v239 offset:0
    ds_read_u16_d16_hi v228, v239 offset:2
    ds_read_u16_d16_hi v230, v239 offset:4
    buffer_load_dwordx4 v[232:233], s[4:7], s86 idxen offen lds
    buffer_load_dwordx4 v[234:235], s[4:7], s86 idxen offen offset:1024 lds
    v_pk_mul_f32 v[2:3], v[178:179], v[130:131]
    v_pk_mul_f32 v[4:5], v[180:181], v[132:133]
    v_pk_mul_f32 v[6:7], v[182:183], v[134:135]
    v_pk_mul_f32 v[8:9], v[184:185], v[136:137]
    v_pk_mul_f32 v[58:59], v[186:187], v[138:139]
    v_pk_mul_f32 v[60:61], v[188:189], v[140:141]
    v_pk_mul_f32 v[62:63], v[190:191], v[142:143]
    v_pk_mul_f32 v[64:65], v[192:193], v[144:145]
    s_waitcnt lgkmcnt(0)
    v_pk_mul_f32 v[114:115], v[178:179], v[226:227] op_sel_hi:[1,0]
    v_pk_mul_f32 v[116:117], v[180:181], v[226:227] op_sel_hi:[1,0]
    v_pk_mul_f32 v[118:119], v[182:183], v[226:227] op_sel_hi:[1,0]
    v_pk_mul_f32 v[120:121], v[184:185], v[226:227] op_sel_hi:[1,0]
    v_pk_mul_f32 v[122:123], v[186:187], v[226:227] op_sel_hi:[1,0]
    v_pk_mul_f32 v[124:125], v[188:189], v[226:227] op_sel_hi:[1,0]
    v_pk_mul_f32 v[126:127], v[190:191], v[226:227] op_sel_hi:[1,0]
    v_pk_mul_f32 v[128:129], v[192:193], v[226:227] op_sel_hi:[1,0]
    v_pk_mul_f32 v[178:179], v[178:179], v[162:163]
    v_pk_mul_f32 v[180:181], v[180:181], v[164:165]
    v_pk_mul_f32 v[182:183], v[182:183], v[166:167]
    v_pk_mul_f32 v[184:185], v[184:185], v[168:169]
    v_pk_mul_f32 v[186:187], v[186:187], v[170:171]
    v_pk_mul_f32 v[188:189], v[188:189], v[172:173]
    v_pk_mul_f32 v[190:191], v[190:191], v[174:175]
    v_pk_mul_f32 v[192:193], v[192:193], v[176:177]
    s_waitcnt vmcnt(16)
    s_cmp_lg_u32 s80, 0
    s_cbranch_scc1 L_relax_7
    s_waitcnt vmcnt(4)
L_relax_7:
    ds_read_b128 v[194:197], v236 offset:2048
    ds_read_b128 v[198:201], v237 offset:2048
    v_pk_mul_f32 v[42:43], v[178:179], v[230:231] op_sel_hi:[1,0]
    v_pk_mul_f32 v[44:45], v[180:181], v[230:231] op_sel_hi:[1,0]
    v_pk_mul_f32 v[46:47], v[182:183], v[230:231] op_sel_hi:[1,0]
    v_pk_mul_f32 v[48:49], v[184:185], v[230:231] op_sel_hi:[1,0]
    v_pk_mul_f32 v[98:99], v[186:187], v[230:231] op_sel_hi:[1,0]
    v_pk_mul_f32 v[100:101], v[188:189], v[230:231] op_sel_hi:[1,0]
    v_pk_mul_f32 v[102:103], v[190:191], v[230:231] op_sel_hi:[1,0]
    v_pk_mul_f32 v[104:105], v[192:193], v[230:231] op_sel_hi:[1,0]
    v_pk_mul_f32 v[50:51], v[178:179], v[228:229] op_sel_hi:[1,0] neg_lo:[0,1] neg_hi:[0,1]
    v_pk_mul_f32 v[52:53], v[180:181], v[228:229] op_sel_hi:[1,0] neg_lo:[0,1] neg_hi:[0,1]
    v_pk_mul_f32 v[54:55], v[182:183], v[228:229] op_sel_hi:[1,0] neg_lo:[0,1] neg_hi:[0,1]
    v_pk_mul_f32 v[56:57], v[184:185], v[228:229] op_sel_hi:[1,0] neg_lo:[0,1] neg_hi:[0,1]
    v_pk_mul_f32 v[106:107], v[186:187], v[228:229] op_sel_hi:[1,0] neg_lo:[0,1] neg_hi:[0,1]
    v_pk_mul_f32 v[108:109], v[188:189], v[228:229] op_sel_hi:[1,0] neg_lo:[0,1] neg_hi:[0,1]
    v_pk_mul_f32 v[110:111], v[190:191], v[228:229] op_sel_hi:[1,0] neg_lo:[0,1] neg_hi:[0,1]
    v_pk_mul_f32 v[112:113], v[192:193], v[228:229] op_sel_hi:[1,0] neg_lo:[0,1] neg_hi:[0,1]
    s_waitcnt lgkmcnt(0)
    v_lshlrev_b32 v178, 16, v194
    v_and_b32 v179, s95, v194
    v_lshlrev_b32 v180, 16, v195
    v_and_b32 v181, s95, v195
    v_lshlrev_b32 v182, 16, v196
    v_and_b32 v183, s95, v196
    v_lshlrev_b32 v184, 16, v197
    v_and_b32 v185, s95, v197
    v_lshlrev_b32 v186, 16, v198
    v_and_b32 v187, s95, v198
    v_lshlrev_b32 v188, 16, v199
    v_and_b32 v189, s95, v199
    v_lshlrev_b32 v190, 16, v200
    v_and_b32 v191, s95, v200
    v_lshlrev_b32 v192, 16, v201
    v_and_b32 v193, s95, v201
    s_add_u32 m0, s93, 2048
    s_nop 0
    buffer_load_dwordx4 v[232:233], s[4:7], s87 idxen offen lds
    buffer_load_dwordx4 v[234:235], s[4:7], s87 idxen offen offset:1024 lds
    v_pk_mul_f32 v[10:11], v[178:179], v[130:131]
    v_pk_mul_f32 v[12:13], v[180:181], v[132:133]
    v_pk_mul_f32 v[14:15], v[182:183], v[134:135]
    v_pk_mul_f32 v[16:17], v[184:185], v[136:137]
    v_pk_mul_f32 v[66:67], v[186:187], v[138:139]
    v_pk_mul_f32 v[68:69], v[188:189], v[140:141]
    v_pk_mul_f32 v[70:71], v[190:191], v[142:143]
    v_pk_mul_f32 v[72:73], v[192:193], v[144:145]
    v_pk_fma_f32 v[114:115], v[178:179], v[228:229], v[114:115] op_sel_hi:[1,0,1]
    v_pk_fma_f32 v[116:117], v[180:181], v[228:229], v[116:117] op_sel_hi:[1,0,1]
    v_pk_fma_f32 v[118:119], v[182:183], v[228:229], v[118:119] op_sel_hi:[1,0,1]
    v_pk_fma_f32 v[120:121], v[184:185], v[228:229], v[120:121] op_sel_hi:[1,0,1]
    v_pk_fma_f32 v[122:123], v[186:187], v[228:229], v[122:123] op_sel_hi:[1,0,1]
    v_pk_fma_f32 v[124:125], v[188:189], v[228:229], v[124:125] op_sel_hi:[1,0,1]
    v_pk_fma_f32 v[126:127], v[190:191], v[228:229], v[126:127] op_sel_hi:[1,0,1]
    v_pk_fma_f32 v[128:129], v[192:193], v[228:229], v[128:129] op_sel_hi:[1,0,1]
    v_pk_mul_f32 v[178:179], v[178:179], v[162:163]
    v_pk_mul_f32 v[180:181], v[180:181], v[164:165]
    v_pk_mul_f32 v[182:183], v[182:183], v[166:167]
    v_pk_mul_f32 v[184:185], v[184:185], v[168:169]
    v_pk_mul_f32 v[186:187], v[186:187], v[170:171]
    v_pk_mul_f32 v[188:189], v[188:189], v[172:173]
    v_pk_mul_f32 v[190:191], v[190:191], v[174:175]
    v_pk_mul_f32 v[192:193], v[192:193], v[176:177]
    s_waitcnt vmcnt(16)
    s_cmp_lg_u32 s80, 0
    s_cbranch_scc1 L_relax_8
    s_waitcnt vmcnt(4)
L_relax_8:
    ds_read_b128 v[194:197], v236 offset:4096
    ds_read_b128 v[198:201], v237 offset:4096
    v_pk_fma_f32 v[50:51], v[178:179], v[226:227], v[50:51] op_sel_hi:[1,0,1]
    v_pk_fma_f32 v[52:53], v[180:181], v[226:227], v[52:53] op_sel_hi:[1,0,1]
    v_pk_fma_f32 v[54:55], v[182:183], v[226:227], v[54:55] op_sel_hi:[1,0,1]
    v_pk_fma_f32 v[56:57], v[184:185], v[226:227], v[56:57] op_sel_hi:[1,0,1]
    v_pk_fma_f32 v[106:107], v[186:187], v[226:227], v[106:107] op_sel_hi:[1,0,1]
    v_pk_fma_f32 v[108:109], v[188:189], v[226:227], v[108:109] op_sel_hi:[1,0,1]
    v_pk_fma_f32 v[110:111], v[190:191], v[226:227], v[110:111] op_sel_hi:[1,0,1]
    v_pk_fma_f32 v[112:113], v[192:193], v[226:227], v[112:113] op_sel_hi:[1,0,1]
    v_pk_mul_f32 v[34:35], v[178:179], v[230:231] op_sel_hi:[1,0] neg_lo:[0,1] neg_hi:[0,1]
    v_pk_mul_f32 v[36:37], v[180:181], v[230:231] op_sel_hi:[1,0] neg_lo:[0,1] neg_hi:[0,1]
    v_pk_mul_f32 v[38:39], v[182:183], v[230:231] op_sel_hi:[1,0] neg_lo:[0,1] neg_hi:[0,1]
    v_pk_mul_f32 v[40:41], v[184:185], v[230:231] op_sel_hi:[1,0] neg_lo:[0,1] neg_hi:[0,1]
    v_pk_mul_f32 v[90:91], v[186:187], v[230:231] op_sel_hi:[1,0] neg_lo:[0,1] neg_hi:[0,1]
    v_pk_mul_f32 v[92:93], v[188:189], v[230:231] op_sel_hi:[1,0] neg_lo:[0,1] neg_hi:[0,1]
    v_pk_mul_f32 v[94:95], v[190:191], v[230:231] op_sel_hi:[1,0] neg_lo:[0,1] neg_hi:[0,1]
    v_pk_mul_f32 v[96:97], v[192:193], v[230:231] op_sel_hi:[1,0] neg_lo:[0,1] neg_hi:[0,1]
    s_waitcnt lgkmcnt(0)
    v_mfma_f32_32x32x16_bf16 v[146:161], v[210:213], v[202:205], 0
    v_lshlrev_b32 v178, 16, v194
    v_and_b32 v179, s95, v194
    v_lshlrev_b32 v180, 16, v195
    v_and_b32 v181, s95, v195
    v_lshlrev_b32 v182, 16, v196
    v_and_b32 v183, s95, v196
    v_lshlrev_b32 v184, 16, v197
    v_and_b32 v185, s95, v197
    v_lshlrev_b32 v186, 16, v198
    v_and_b32 v187, s95, v198
    v_lshlrev_b32 v188, 16, v199
    v_and_b32 v189, s95, v199
    v_lshlrev_b32 v190, 16, v200
    v_and_b32 v191, s95, v200
    v_lshlrev_b32 v192, 16, v201
    v_and_b32 v193, s95, v201
    s_add_u32 m0, s93, 4096
    ds_read_b128 v[202:205], v238 offset:1024
    buffer_load_dwordx4 v[232:233], s[4:7], s88 idxen offen lds
    buffer_load_dwordx4 v[234:235], s[4:7], s88 idxen offen offset:1024 lds
    s_cmp_eq_u32 s91, 1
    s_cselect_b32 s98, s83, 256
    v_add_u32 v240, s98, v240
    ds_read_u16 v232, v240 offset:6
    ds_read_u16 v234, v240 offset:134
    v_pk_mul_f32 v[18:19], v[178:179], v[130:131]
    v_pk_mul_f32 v[20:21], v[180:181], v[132:133]
    v_pk_mul_f32 v[22:23], v[182:183], v[134:135]
    v_pk_mul_f32 v[24:25], v[184:185], v[136:137]
    v_pk_mul_f32 v[74:75], v[186:187], v[138:139]
    v_pk_mul_f32 v[76:77], v[188:189], v[140:141]
    v_pk_mul_f32 v[78:79], v[190:191], v[142:143]
    v_pk_mul_f32 v[80:81], v[192:193], v[144:145]
    v_pk_fma_f32 v[114:115], v[178:179], v[230:231], v[114:115] op_sel_hi:[1,0,1]
    v_pk_fma_f32 v[116:117], v[180:181], v[230:231], v[116:117] op_sel_hi:[1,0,1]
    v_pk_fma_f32 v[118:119], v[182:183], v[230:231], v[118:119] op_sel_hi:[1,0,1]
    v_pk_fma_f32 v[120:121], v[184:185], v[230:231], v[120:121] op_sel_hi:[1,0,1]
    v_pk_fma_f32 v[122:123], v[186:187], v[230:231], v[122:123] op_sel_hi:[1,0,1]
    v_pk_fma_f32 v[124:125], v[188:189], v[230:231], v[124:125] op_sel_hi:[1,0,1]
    v_pk_fma_f32 v[126:127], v[190:191], v[230:231], v[126:127] op_sel_hi:[1,0,1]
    v_pk_fma_f32 v[128:129], v[192:193], v[230:231], v[128:129] op_sel_hi:[1,0,1]
    v_pk_mul_f32 v[178:179], v[178:179], v[162:163]
    v_pk_mul_f32 v[180:181], v[180:181], v[164:165]
    v_pk_mul_f32 v[182:183], v[182:183], v[166:167]
    v_pk_mul_f32 v[184:185], v[184:185], v[168:169]
    v_pk_mul_f32 v[186:187], v[186:187], v[170:171]
    v_pk_mul_f32 v[188:189], v[188:189], v[172:173]
    v_pk_mul_f32 v[190:191], v[190:191], v[174:175]
    v_pk_mul_f32 v[192:193], v[192:193], v[176:177]
    v_pk_fma_f32 v[34:35], v[178:179], v[228:229], v[34:35] op_sel_hi:[1,0,1]
    v_pk_fma_f32 v[36:37], v[180:181], v[228:229], v[36:37] op_sel_hi:[1,0,1]
    v_pk_fma_f32 v[38:39], v[182:183], v[228:229], v[38:39] op_sel_hi:[1,0,1]
    v_pk_fma_f32 v[40:41], v[184:185], v[228:229], v[40:41] op_sel_hi:[1,0,1]
    v_pk_fma_f32 v[90:91], v[186:187], v[228:229], v[90:91] op_sel_hi:[1,0,1]
    v_pk_fma_f32 v[92:93], v[188:189], v[228:229], v[92:93] op_sel_hi:[1,0,1]
    v_pk_fma_f32 v[94:95], v[190:191], v[228:229], v[94:95] op_sel_hi:[1,0,1]
    v_pk_fma_f32 v[96:97], v[192:193], v[228:229], v[96:97] op_sel_hi:[1,0,1]
    s_waitcnt vmcnt(4)
    ds_read_b128 v[194:197], v236 offset:0
    ds_read_b128 v[198:201], v237 offset:0
    v_add_u32 v238, 1024, v238
    v_add_u32 v239, 256, v239
    v_pk_fma_f32 v[42:43], v[178:179], v[226:227], v[42:43] op_sel_hi:[1,0,1] neg_lo:[0,1,0] neg_hi:[0,1,0]
    v_pk_fma_f32 v[44:45], v[180:181], v[226:227], v[44:45] op_sel_hi:[1,0,1] neg_lo:[0,1,0] neg_hi:[0,1,0]
    v_pk_fma_f32 v[46:47], v[182:183], v[226:227], v[46:47] op_sel_hi:[1,0,1] neg_lo:[0,1,0] neg_hi:[0,1,0]
    v_pk_fma_f32 v[48:49], v[184:185], v[226:227], v[48:49] op_sel_hi:[1,0,1] neg_lo:[0,1,0] neg_hi:[0,1,0]
    v_pk_fma_f32 v[98:99], v[186:187], v[226:227], v[98:99] op_sel_hi:[1,0,1] neg_lo:[0,1,0] neg_hi:[0,1,0]
    v_pk_fma_f32 v[100:101], v[188:189], v[226:227], v[100:101] op_sel_hi:[1,0,1] neg_lo:[0,1,0] neg_hi:[0,1,0]
    v_pk_fma_f32 v[102:103], v[190:191], v[226:227], v[102:103] op_sel_hi:[1,0,1] neg_lo:[0,1,0] neg_hi:[0,1,0]
    v_pk_fma_f32 v[104:105], v[192:193], v[226:227], v[104:105] op_sel_hi:[1,0,1] neg_lo:[0,1,0] neg_hi:[0,1,0]
    v_pk_mul_f32 v[26:27], v[114:115], v[146:147]
    v_pk_mul_f32 v[28:29], v[116:117], v[148:149]
    v_pk_mul_f32 v[30:31], v[118:119], v[150:151]
    v_pk_mul_f32 v[32:33], v[120:121], v[152:153]
    v_pk_mul_f32 v[82:83], v[122:123], v[154:155]
    v_pk_mul_f32 v[84:85], v[124:125], v[156:157]
    v_pk_mul_f32 v[86:87], v[126:127], v[158:159]
    v_pk_mul_f32 v[88:89], v[128:129], v[160:161]
LB_vec:
    s_sub_u32 s91, s91, 1
    s_waitcnt lgkmcnt(0)
    v_lshlrev_b32 v178, 16, v194
    v_mfma_f32_32x32x16_bf16 v[130:145], v[218:221], v[202:205], 0
    v_and_b32 v179, s95, v194
    v_lshlrev_b32 v180, 16, v195
    v_and_b32 v181, s95, v195
    v_lshlrev_b32 v182, 16, v196
    v_and_b32 v183, s95, v196
    v_lshlrev_b32 v184, 16, v197
    v_mfma_f32_32x32x16_bf16 v[162:177], v[222:225], v[202:205], 0
    v_and_b32 v185, s95, v197
    v_lshlrev_b32 v186, 16, v198
    v_and_b32 v187, s95, v198
    v_lshlrev_b32 v188, 16, v199
    v_and_b32 v189, s95, v199
    v_lshlrev_b32 v190, 16, v200
    v_and_b32 v191, s95, v200
    v_lshlrev_b32 v192, 16, v201
    v_and_b32 v193, s95, v201
    s_add_u32 m0, s93, 0
    ds_read_u16_d16_hi v226, v239 offset:0
    ds_read_u16_d16_hi v228, v239 offset:2
    ds_read_u16_d16_hi v230, v239 offset:4
    buffer_load_dwordx4 v[232:233], s[4:7], s86 idxen offen lds
    buffer_load_dwordx4 v[234:235], s[4:7], s86 idxen offen offset:1024 lds
    v_pk_fma_f32 v[2:3], v[178:179], v[130:131], v[2:3]
    v_pk_fma_f32 v[4:5], v[180:181], v[132:133], v[4:5]
    v_pk_fma_f32 v[6:7], v[182:183], v[134:135], v[6:7]
    v_pk_fma_f32 v[8:9], v[184:185], v[136:137], v[8:9]
    v_pk_fma_f32 v[58:59], v[186:187], v[138:139], v[58:59]
    v_pk_fma_f32 v[60:61], v[188:189], v[140:141], v[60:61]
    v_pk_fma_f32 v[62:63], v[190:191], v[142:143], v[62:63]
    v_pk_fma_f32 v[64:65], v[192:193], v[144:145], v[64:65]
    s_waitcnt lgkmcnt(0)
    v_pk_mul_f32 v[114:115], v[178:179], v[226:227] op_sel_hi:[1,0]
    v_pk_mul_f32 v[116:117], v[180:181], v[226:227] op_sel_hi:[1,0]
    v_pk_mul_f32 v[118:119], v[182:183], v[226:227] op_sel_hi:[1,0]
    v_pk_mul_f32 v[120:121], v[184:185], v[226:227] op_sel_hi:[1,0]
    v_pk_mul_f32 v[122:123], v[186:187], v[226:227] op_sel_hi:[1,0]
    v_pk_mul_f32 v[124:125], v[188:189], v[226:227] op_sel_hi:[1,0]
    v_pk_mul_f32 v[126:127], v[190:191], v[226:227] op_sel_hi:[1,0]
    v_pk_mul_f32 v[128:129], v[192:193], v[226:227] op_sel_hi:[1,0]
    v_pk_mul_f32 v[178:179], v[178:179], v[162:163]
    v_pk_mul_f32 v[180:181], v[180:181], v[164:165]
    v_pk_mul_f32 v[182:183], v[182:183], v[166:167]
    v_pk_mul_f32 v[184:185], v[184:185], v[168:169]
    v_pk_mul_f32 v[186:187], v[186:187], v[170:171]
    v_pk_mul_f32 v[188:189], v[188:189], v[172:173]
    v_pk_mul_f32 v[190:191], v[190:191], v[174:175]
    v_pk_mul_f32 v[192:193], v[192:193], v[176:177]
    s_waitcnt vmcnt(4)
    ds_read_b128 v[194:197], v236 offset:2048
    ds_read_b128 v[198:201], v237 offset:2048
    s_sub_u32 s84, s84, 1
    s_cmp_eq_u32 s84, s89
    s_cbranch_scc1 LB_meet0
LB_met0:
    v_pk_fma_f32 v[42:43], v[178:179], v[230:231], v[42:43] op_sel_hi:[1,0,1]
    v_pk_fma_f32 v[44:45], v[180:181], v[230:231], v[44:45] op_sel_hi:[1,0,1]
    v_pk_fma_f32 v[46:47], v[182:183], v[230:231], v[46:47] op_sel_hi:[1,0,1]
    v_pk_fma_f32 v[48:49], v[184:185], v[230:231], v[48:49] op_sel_hi:[1,0,1]
    v_pk_fma_f32 v[98:99], v[186:187], v[230:231], v[98:99] op_sel_hi:[1,0,1]
    v_pk_fma_f32 v[100:101], v[188:189], v[230:231], v[100:101] op_sel_hi:[1,0,1]
    v_pk_fma_f32 v[102:103], v[190:191], v[230:231], v[102:103] op_sel_hi:[1,0,1]
    v_pk_fma_f32 v[104:105], v[192:193], v[230:231], v[104:105] op_sel_hi:[1,0,1]
    v_pk_fma_f32 v[50:51], v[178:179], v[228:229], v[50:51] op_sel_hi:[1,0,1] neg_lo:[0,1,0] neg_hi:[0,1,0]
    v_pk_fma_f32 v[52:53], v[180:181], v[228:229], v[52:53] op_sel_hi:[1,0,1] neg_lo:[0,1,0] neg_hi:[0,1,0]
    v_pk_fma_f32 v[54:55], v[182:183], v[228:229], v[54:55] op_sel_hi:[1,0,1] neg_lo:[0,1,0] neg_hi:[0,1,0]
    v_pk_fma_f32 v[56:57], v[184:185], v[228:229], v[56:57] op_sel_hi:[1,0,1] neg_lo:[0,1,0] neg_hi:[0,1,0]
    v_pk_fma_f32 v[106:107], v[186:187], v[228:229], v[106:107] op_sel_hi:[1,0,1] neg_lo:[0,1,0] neg_hi:[0,1,0]
    v_pk_fma_f32 v[108:109], v[188:189], v[228:229], v[108:109] op_sel_hi:[1,0,1] neg_lo:[0,1,0] neg_hi:[0,1,0]
    v_pk_fma_f32 v[110:111], v[190:191], v[228:229], v[110:111] op_sel_hi:[1,0,1] neg_lo:[0,1,0] neg_hi:[0,1,0]
    v_pk_fma_f32 v[112:113], v[192:193], v[228:229], v[112:113] op_sel_hi:[1,0,1] neg_lo:[0,1,0] neg_hi:[0,1,0]
    s_waitcnt lgkmcnt(0)
    v_lshlrev_b32 v178, 16, v194
    v_and_b32 v179, s95, v194
    v_lshlrev_b32 v180, 16, v195
    v_and_b32 v181, s95, v195
    v_lshlrev_b32 v182, 16, v196
    v_and_b32 v183, s95, v196
    v_lshlrev_b32 v184, 16, v197
    v_and_b32 v185, s95, v197
    v_lshlrev_b32 v186, 16, v198
    v_and_b32 v187, s95, v198
    v_lshlrev_b32 v188, 16, v199
    v_and_b32 v189, s95, v199
    v_lshlrev_b32 v190, 16, v200
    v_and_b32 v191, s95, v200
    v_lshlrev_b32 v192, 16, v201
    v_and_b32 v193, s95, v201
    s_add_u32 m0, s93, 2048
    s_nop 0
    buffer_load_dwordx4 v[232:233], s[4:7], s87 idxen offen lds
    buffer_load_dwordx4 v[234:235], s[4:7], s87 idxen offen offset:1024 lds
    v_pk_fma_f32 v[10:11], v[178:179], v[130:131], v[10:11]
    v_pk_fma_f32 v[12:13], v[180:181], v[132:133], v[12:13]
    v_pk_fma_f32 v[14:15], v[182:183], v[134:135], v[14:15]
    v_pk_fma_f32 v[16:17], v[184:185], v[136:137], v[16:17]
    v_pk_fma_f32 v[66:67], v[186:187], v[138:139], v[66:67]
    v_pk_fma_f32 v[68:69], v[188:189], v[140:141], v[68:69]
    v_pk_fma_f32 v[70:71], v[190:191], v[142:143], v[70:71]
    v_pk_fma_f32 v[72:73], v[192:193], v[144:145], v[72:73]
    v_pk_fma_f32 v[114:115], v[178:179], v[228:229], v[114:115] op_sel_hi:[1,0,1]
    v_pk_fma_f32 v[116:117], v[180:181], v[228:229], v[116:117] op_sel_hi:[1,0,1]
    v_pk_fma_f32 v[118:119], v[182:183], v[228:229], v[118:119] op_sel_hi:[1,0,1]
    v_pk_fma_f32 v[120:121], v[184:185], v[228:229], v[120:121] op_sel_hi:[1,0,1]
    v_pk_fma_f32 v[122:123], v[186:187], v[228:229], v[122:123] op_sel_hi:[1,0,1]
    v_pk_fma_f32 v[124:125], v[188:189], v[228:229], v[124:125] op_sel_hi:[1,0,1]
    v_pk_fma_f32 v[126:127], v[190:191], v[228:229], v[126:127] op_sel_hi:[1,0,1]
    v_pk_fma_f32 v[128:129], v[192:193], v[228:229], v[128:129] op_sel_hi:[1,0,1]
    v_pk_mul_f32 v[178:179], v[178:179], v[162:163]
    v_pk_mul_f32 v[180:181], v[180:181], v[164:165]
    v_pk_mul_f32 v[182:183], v[182:183], v[166:167]
    v_pk_mul_f32 v[184:185], v[184:185], v[168:169]
    v_pk_mul_f32 v[186:187], v[186:187], v[170:171]
    v_pk_mul_f32 v[188:189], v[188:189], v[172:173]
    v_pk_mul_f32 v[190:191], v[190:191], v[174:175]
    v_pk_mul_f32 v[192:193], v[192:193], v[176:177]
    s_waitcnt vmcnt(4)
    ds_read_b128 v[194:197], v236 offset:4096
    ds_read_b128 v[198:201], v237 offset:4096
    s_sub_u32 s84, s84, 1
    s_cmp_eq_u32 s84, s89
    s_cbranch_scc1 LB_meet1
LB_met1:
    v_pk_fma_f32 v[50:51], v[178:179], v[226:227], v[50:51] op_sel_hi:[1,0,1]
    v_pk_fma_f32 v[52:53], v[180:181], v[226:227], v[52:53] op_sel_hi:[1,0,1]
    v_pk_fma_f32 v[54:55], v[182:183], v[226:227], v[54:55] op_sel_hi:[1,0,1]
    v_pk_fma_f32 v[56:57], v[184:185], v[226:227], v[56:57] op_sel_hi:[1,0,1]
    v_pk_fma_f32 v[106:107], v[186:187], v[226:227], v[106:107] op_sel_hi:[1,0,1]
    v_pk_fma_f32 v[108:109], v[188:189], v[226:227], v[108:109] op_sel_hi:[1,0,1]
    v_pk_fma_f32 v[110:111], v[190:191], v[226:227], v[110:111] op_sel_hi:[1,0,1]
    v_pk_fma_f32 v[112:113], v[192:193], v[226:227], v[112:113] op_sel_hi:[1,0,1]
    v_pk_fma_f32 v[34:35], v[178:179], v[230:231], v[34:35] op_sel_hi:[1,0,1] neg_lo:[0,1,0] neg_hi:[0,1,0]
    v_pk_fma_f32 v[36:37], v[180:181], v[230:231], v[36:37] op_sel_hi:[1,0,1] neg_lo:[0,1,0] neg_hi:[0,1,0]
    v_pk_fma_f32 v[38:39], v[182:183], v[230:231], v[38:39] op_sel_hi:[1,0,1] neg_lo:[0,1,0] neg_hi:[0,1,0]
    v_pk_fma_f32 v[40:41], v[184:185], v[230:231], v[40:41] op_sel_hi:[1,0,1] neg_lo:[0,1,0] neg_hi:[0,1,0]
    v_pk_fma_f32 v[90:91], v[186:187], v[230:231], v[90:91] op_sel_hi:[1,0,1] neg_lo:[0,1,0] neg_hi:[0,1,0]
    v_pk_fma_f32 v[92:93], v[188:189], v[230:231], v[92:93] op_sel_hi:[1,0,1] neg_lo:[0,1,0] neg_hi:[0,1,0]
    v_pk_fma_f32 v[94:95], v[190:191], v[230:231], v[94:95] op_sel_hi:[1,0,1] neg_lo:[0,1,0] neg_hi:[0,1,0]
    v_pk_fma_f32 v[96:97], v[192:193], v[230:231], v[96:97] op_sel_hi:[1,0,1] neg_lo:[0,1,0] neg_hi:[0,1,0]
    s_waitcnt lgkmcnt(0)
    v_mfma_f32_32x32x16_bf16 v[146:161], v[210:213], v[202:205], 0
    v_lshlrev_b32 v178, 16, v194
    v_and_b32 v179, s95, v194
    v_lshlrev_b32 v180, 16, v195
    v_and_b32 v181, s95, v195
    v_lshlrev_b32 v182, 16, v196
    v_and_b32 v183, s95, v196
    v_lshlrev_b32 v184, 16, v197
    v_and_b32 v185, s95, v197
    v_lshlrev_b32 v186, 16, v198
    v_and_b32 v187, s95, v198
    v_lshlrev_b32 v188, 16, v199
    v_and_b32 v189, s95, v199
    v_lshlrev_b32 v190, 16, v200
    v_and_b32 v191, s95, v200
    v_lshlrev_b32 v192, 16, v201
    v_and_b32 v193, s95, v201
    s_add_u32 m0, s93, 4096
    ds_read_b128 v[202:205], v238 offset:1024
    buffer_load_dwordx4 v[232:233], s[4:7], s88 idxen offen lds
    buffer_load_dwordx4 v[234:235], s[4:7], s88 idxen offen offset:1024 lds
    s_cmp_eq_u32 s91, 1
    s_cselect_b32 s98, s83, 256
    v_add_u32 v240, s98, v240
    ds_read_u16 v232, v240 offset:6
    ds_read_u16 v234, v240 offset:134
    v_pk_fma_f32 v[18:19], v[178:179], v[130:131], v[18:19]
    v_pk_fma_f32 v[20:21], v[180:181], v[132:133], v[20:21]
    v_pk_fma_f32 v[22:23], v[182:183], v[134:135], v[22:23]
    v_pk_fma_f32 v[24:25], v[184:185], v[136:137], v[24:25]
    v_pk_fma_f32 v[74:75], v[186:187], v[138:139], v[74:75]
    v_pk_fma_f32 v[76:77], v[188:189], v[140:141], v[76:77]
    v_pk_fma_f32 v[78:79], v[190:191], v[142:143], v[78:79]
    v_pk_fma_f32 v[80:81], v[192:193], v[144:145], v[80:81]
    v_pk_fma_f32 v[114:115], v[178:179], v[230:231], v[114:115] op_sel_hi:[1,0,1]
    v_pk_fma_f32 v[116:117], v[180:181], v[230:231], v[116:117] op_sel_hi:[1,0,1]
    v_pk_fma_f32 v[118:119], v[182:183], v[230:231], v[118:119] op_sel_hi:[1,0,1]
    v_pk_fma_f32 v[120:121], v[184:185], v[230:231], v[120:121] op_sel_hi:[1,0,1]
    v_pk_fma_f32 v[122:123], v[186:187], v[230:231], v[122:123] op_sel_hi:[1,0,1]
    v_pk_fma_f32 v[124:125], v[188:189], v[230:231], v[124:125] op_sel_hi:[1,0,1]
    v_pk_fma_f32 v[126:127], v[190:191], v[230:231], v[126:127] op_sel_hi:[1,0,1]
    v_pk_fma_f32 v[128:129], v[192:193], v[230:231], v[128:129] op_sel_hi:[1,0,1]
    v_pk_mul_f32 v[178:179], v[178:179], v[162:163]
    v_pk_mul_f32 v[180:181], v[180:181], v[164:165]
    v_pk_mul_f32 v[182:183], v[182:183], v[166:167]
    v_pk_mul_f32 v[184:185], v[184:185], v[168:169]
    v_pk_mul_f32 v[186:187], v[186:187], v[170:171]
    v_pk_mul_f32 v[188:189], v[188:189], v[172:173]
    v_pk_mul_f32 v[190:191], v[190:191], v[174:175]
    v_pk_mul_f32 v[192:193], v[192:193], v[176:177]
    v_pk_fma_f32 v[34:35], v[178:179], v[228:229], v[34:35] op_sel_hi:[1,0,1]
    v_pk_fma_f32 v[36:37], v[180:181], v[228:229], v[36:37] op_sel_hi:[1,0,1]
    v_pk_fma_f32 v[38:39], v[182:183], v[228:229], v[38:39] op_sel_hi:[1,0,1]
    v_pk_fma_f32 v[40:41], v[184:185], v[228:229], v[40:41] op_sel_hi:[1,0,1]
    v_pk_fma_f32 v[90:91], v[186:187], v[228:229], v[90:91] op_sel_hi:[1,0,1]
    v_pk_fma_f32 v[92:93], v[188:189], v[228:229], v[92:93] op_sel_hi:[1,0,1]
    v_pk_fma_f32 v[94:95], v[190:191], v[228:229], v[94:95] op_sel_hi:[1,0,1]
    v_pk_fma_f32 v[96:97], v[192:193], v[228:229], v[96:97] op_sel_hi:[1,0,1]
    s_waitcnt vmcnt(4)
    ds_read_b128 v[194:197], v236 offset:0
    ds_read_b128 v[198:201], v237 offset:0
    v_add_u32 v238, 1024, v238
    v_add_u32 v239, 256, v239
    s_sub_u32 s84, s84, 1
    s_cmp_eq_u32 s84, s89
    s_cbranch_scc1 LB_meet2
LB_met2:
    v_pk_fma_f32 v[42:43], v[178:179], v[226:227], v[42:43] op_sel_hi:[1,0,1] neg_lo:[0,1,0] neg_hi:[0,1,0]
    v_pk_fma_f32 v[44:45], v[180:181], v[226:227], v[44:45] op_sel_hi:[1,0,1] neg_lo:[0,1,0] neg_hi:[0,1,0]
    v_pk_fma_f32 v[46:47], v[182:183], v[226:227], v[46:47] op_sel_hi:[1,0,1] neg_lo:[0,1,0] neg_hi:[0,1,0]
    v_pk_fma_f32 v[48:49], v[184:185], v[226:227], v[48:49] op_sel_hi:[1,0,1] neg_lo:[0,1,0] neg_hi:[0,1,0]
    v_pk_fma_f32 v[98:99], v[186:187], v[226:227], v[98:99] op_sel_hi:[1,0,1] neg_lo:[0,1,0] neg_hi:[0,1,0]
    v_pk_fma_f32 v[100:101], v[188:189], v[226:227], v[100:101] op_sel_hi:[1,0,1] neg_lo:[0,1,0] neg_hi:[0,1,0]
    v_pk_fma_f32 v[102:103], v[190:191], v[226:227], v[102:103] op_sel_hi:[1,0,1] neg_lo:[0,1,0] neg_hi:[0,1,0]
    v_pk_fma_f32 v[104:105], v[192:193], v[226:227], v[104:105] op_sel_hi:[1,0,1] neg_lo:[0,1,0] neg_hi:[0,1,0]
    v_pk_fma_f32 v[26:27], v[114:115], v[146:147], v[26:27]
    v_pk_fma_f32 v[28:29], v[116:117], v[148:149], v[28:29]
    v_pk_fma_f32 v[30:31], v[118:119], v[150:151], v[30:31]
    v_pk_fma_f32 v[32:33], v[120:121], v[152:153], v[32:33]
    v_pk_fma_f32 v[82:83], v[122:123], v[154:155], v[82:83]
    v_pk_fma_f32 v[84:85], v[124:125], v[156:157], v[84:85]
    v_pk_fma_f32 v[86:87], v[126:127], v[158:159], v[86:87]
    v_pk_fma_f32 v[88:89], v[128:129], v[160:161], v[88:89]
    s_cmp_lg_u32 s91, 1
    s_cbranch_scc1 LB_vec
    s_waitcnt lgkmcnt(0)
    v_lshlrev_b32 v178, 16, v194
    v_mfma_f32_32x32x16_bf16 v[130:145], v[218:221], v[202:205], 0
    v_and_b32 v179, s95, v194
    v_lshlrev_b32 v180, 16, v195
    v_and_b32 v181, s95, v195
    v_lshlrev_b32 v182, 16, v196
    v_and_b32 v183, s95, v196
    v_lshlrev_b32 v184, 16, v197
    v_mfma_f32_32x32x16_bf16 v[162:177], v[222:225], v[202:205], 0
    v_and_b32 v185, s95, v197
    v_lshlrev_b32 v186, 16, v198
    v_and_b32 v187, s95, v198
    v_lshlrev_b32 v188, 16, v199
    v_and_b32 v189, s95, v199
    v_lshlrev_b32 v190, 16, v200
    v_and_b32 v191, s95, v200
    v_lshlrev_b32 v192, 16, v201
    v_and_b32 v193, s95, v201
    s_add_u32 m0, s93, 0
    ds_read_u16_d16_hi v226, v239 offset:0
    ds_read_u16_d16_hi v228, v239 offset:2
    ds_read_u16_d16_hi v230, v239 offset:4
    buffer_load_dwordx4 v[232:233], s[4:7], s85 idxen offen lds
    buffer_load_dwordx4 v[234:235], s[4:7], s85 idxen offen offset:1024 lds
    ds_read_u16 v232, v240 offset:262
    ds_read_u16 v234, v240 offset:390
    v_pk_fma_f32 v[2:3], v[178:179], v[130:131], v[2:3]
    v_pk_fma_f32 v[4:5], v[180:181], v[132:133], v[4:5]
    v_pk_fma_f32 v[6:7], v[182:183], v[134:135], v[6:7]
    v_pk_fma_f32 v[8:9], v[184:185], v[136:137], v[8:9]
    v_pk_fma_f32 v[58:59], v[186:187], v[138:139], v[58:59]
    v_pk_fma_f32 v[60:61], v[188:189], v[140:141], v[60:61]
    v_pk_fma_f32 v[62:63], v[190:191], v[142:143], v[62:63]
    v_pk_fma_f32 v[64:65], v[192:193], v[144:145], v[64:65]
    s_waitcnt lgkmcnt(2)
    v_pk_mul_f32 v[114:115], v[178:179], v[226:227] op_sel_hi:[1,0]
    v_pk_mul_f32 v[116:117], v[180:181], v[226:227] op_sel_hi:[1,0]
    v_pk_mul_f32 v[118:119], v[182:183], v[226:227] op_sel_hi:[1,0]
    v_pk_mul_f32 v[120:121], v[184:185], v[226:227] op_sel_hi:[1,0]
    v_pk_mul_f32 v[122:123], v[186:187], v[226:227] op_sel_hi:[1,0]
    v_pk_mul_f32 v[124:125], v[188:189], v[226:227] op_sel_hi:[1,0]
    v_pk_mul_f32 v[126:127], v[190:191], v[226:227] op_sel_hi:[1,0]
    v_pk_mul_f32 v[128:129], v[192:193], v[226:227] op_sel_hi:[1,0]
    v_pk_mul_f32 v[178:179], v[178:179], v[162:163]
    v_pk_mul_f32 v[180:181], v[180:181], v[164:165]
    v_pk_mul_f32 v[182:183], v[182:183], v[166:167]
    v_pk_mul_f32 v[184:185], v[184:185], v[168:169]
    v_pk_mul_f32 v[186:187], v[186:187], v[170:171]
    v_pk_mul_f32 v[188:189], v[188:189], v[172:173]
    v_pk_mul_f32 v[190:191], v[190:191], v[174:175]
    v_pk_mul_f32 v[192:193], v[192:193], v[176:177]
    s_waitcnt vmcnt(4)
    ds_read_b128 v[194:197], v236 offset:2048
    ds_read_b128 v[198:201], v237 offset:2048
    v_pk_fma_f32 v[42:43], v[178:179], v[230:231], v[42:43] op_sel_hi:[1,0,1]
    v_pk_fma_f32 v[44:45], v[180:181], v[230:231], v[44:45] op_sel_hi:[1,0,1]
    v_pk_fma_f32 v[46:47], v[182:183], v[230:231], v[46:47] op_sel_hi:[1,0,1]
    v_pk_fma_f32 v[48:49], v[184:185], v[230:231], v[48:49] op_sel_hi:[1,0,1]
    v_pk_fma_f32 v[98:99], v[186:187], v[230:231], v[98:99] op_sel_hi:[1,0,1]
    v_pk_fma_f32 v[100:101], v[188:189], v[230:231], v[100:101] op_sel_hi:[1,0,1]
    v_pk_fma_f32 v[102:103], v[190:191], v[230:231], v[102:103] op_sel_hi:[1,0,1]
    v_pk_fma_f32 v[104:105], v[192:193], v[230:231], v[104:105] op_sel_hi:[1,0,1]
    v_pk_fma_f32 v[50:51], v[178:179], v[228:229], v[50:51] op_sel_hi:[1,0,1] neg_lo:[0,1,0] neg_hi:[0,1,0]
    v_pk_fma_f32 v[52:53], v[180:181], v[228:229], v[52:53] op_sel_hi:[1,0,1] neg_lo:[0,1,0] neg_hi:[0,1,0]
    v_pk_fma_f32 v[54:55], v[182:183], v[228:229], v[54:55] op_sel_hi:[1,0,1] neg_lo:[0,1,0] neg_hi:[0,1,0]
    v_pk_fma_f32 v[56:57], v[184:185], v[228:229], v[56:57] op_sel_hi:[1,0,1] neg_lo:[0,1,0] neg_hi:[0,1,0]
    v_pk_fma_f32 v[106:107], v[186:187], v[228:229], v[106:107] op_sel_hi:[1,0,1] neg_lo:[0,1,0] neg_hi:[0,1,0]
    v_pk_fma_f32 v[108:109], v[188:189], v[228:229], v[108:109] op_sel_hi:[1,0,1] neg_lo:[0,1,0] neg_hi:[0,1,0]
    v_pk_fma_f32 v[110:111], v[190:191], v[228:229], v[110:111] op_sel_hi:[1,0,1] neg_lo:[0,1,0] neg_hi:[0,1,0]
    v_pk_fma_f32 v[112:113], v[192:193], v[228:229], v[112:113] op_sel_hi:[1,0,1] neg_lo:[0,1,0] neg_hi:[0,1,0]
    s_waitcnt lgkmcnt(0)
    v_lshlrev_b32 v178, 16, v194
    v_and_b32 v179, s95, v194
    v_lshlrev_b32 v180, 16, v195
    v_and_b32 v181, s95, v195
    v_lshlrev_b32 v182, 16, v196
    v_and_b32 v183, s95, v196
    v_lshlrev_b32 v184, 16, v197
    v_and_b32 v185, s95, v197
    v_lshlrev_b32 v186, 16, v198
    v_and_b32 v187, s95, v198
    v_lshlrev_b32 v188, 16, v199
    v_and_b32 v189, s95, v199
    v_lshlrev_b32 v190, 16, v200
    v_and_b32 v191, s95, v200
    v_lshlrev_b32 v192, 16, v201
    v_and_b32 v193, s95, v201
    s_add_u32 m0, s93, 2048
    s_nop 0
    buffer_load_dwordx4 v[232:233], s[4:7], s85 idxen offen lds
    buffer_load_dwordx4 v[234:235], s[4:7], s85 idxen offen offset:1024 lds
    ds_read_u16 v232, v240 offset:518
    ds_read_u16 v234, v240 offset:646
    v_pk_fma_f32 v[10:11], v[178:179], v[130:131], v[10:11]
    v_pk_fma_f32 v[12:13], v[180:181], v[132:133], v[12:13]
    v_pk_fma_f32 v[14:15], v[182:183], v[134:135], v[14:15]
    v_pk_fma_f32 v[16:17], v[184:185], v[136:137], v[16:17]
    v_pk_fma_f32 v[66:67], v[186:187], v[138:139], v[66:67]
    v_pk_fma_f32 v[68:69], v[188:189], v[140:141], v[68:69]
    v_pk_fma_f32 v[70:71], v[190:191], v[142:143], v[70:71]
    v_pk_fma_f32 v[72:73], v[192:193], v[144:145], v[72:73]
    v_pk_fma_f32 v[114:115], v[178:179], v[228:229], v[114:115] op_sel_hi:[1,0,1]
    v_pk_fma_f32 v[116:117], v[180:181], v[228:229], v[116:117] op_sel_hi:[1,0,1]
    v_pk_fma_f32 v[118:119], v[182:183], v[228:229], v[118:119] op_sel_hi:[1,0,1]
    v_pk_fma_f32 v[120:121], v[184:185], v[228:229], v[120:121] op_sel_hi:[1,0,1]
    v_pk_fma_f32 v[122:123], v[186:187], v[228:229], v[122:123] op_sel_hi:[1,0,1]
    v_pk_fma_f32 v[124:125], v[188:189], v[228:229], v[124:125] op_sel_hi:[1,0,1]
    v_pk_fma_f32 v[126:127], v[190:191], v[228:229], v[126:127] op_sel_hi:[1,0,1]
    v_pk_fma_f32 v[128:129], v[192:193], v[228:229], v[128:129] op_sel_hi:[1,0,1]
    v_pk_mul_f32 v[178:179], v[178:179], v[162:163]
    v_pk_mul_f32 v[180:181], v[180:181], v[164:165]
    v_pk_mul_f32 v[182:183], v[182:183], v[166:167]
    v_pk_mul_f32 v[184:185], v[184:185], v[168:169]
    v_pk_mul_f32 v[186:187], v[186:187], v[170:171]
    v_pk_mul_f32 v[188:189], v[188:189], v[172:173]
    v_pk_mul_f32 v[190:191], v[190:191], v[174:175]
    v_pk_mul_f32 v[192:193], v[192:193], v[176:177]
    s_waitcnt vmcnt(4)
    ds_read_b128 v[194:197], v236 offset:4096
    ds_read_b128 v[198:201], v237 offset:4096
    v_pk_fma_f32 v[50:51], v[178:179], v[226:227], v[50:51] op_sel_hi:[1,0,1]
    v_pk_fma_f32 v[52:53], v[180:181], v[226:227], v[52:53] op_sel_hi:[1,0,1]
    v_pk_fma_f32 v[54:55], v[182:183], v[226:227], v[54:55] op_sel_hi:[1,0,1]
    v_pk_fma_f32 v[56:57], v[184:185], v[226:227], v[56:57] op_sel_hi:[1,0,1]
    v_pk_fma_f32 v[106:107], v[186:187], v[226:227], v[106:107] op_sel_hi:[1,0,1]
    v_pk_fma_f32 v[108:109], v[188:189], v[226:227], v[108:109] op_sel_hi:[1,0,1]
    v_pk_fma_f32 v[110:111], v[190:191], v[226:227], v[110:111] op_sel_hi:[1,0,1]
    v_pk_fma_f32 v[112:113], v[192:193], v[226:227], v[112:113] op_sel_hi:[1,0,1]
    v_pk_fma_f32 v[34:35], v[178:179], v[230:231], v[34:35] op_sel_hi:[1,0,1] neg_lo:[0,1,0] neg_hi:[0,1,0]
    v_pk_fma_f32 v[36:37], v[180:181], v[230:231], v[36:37] op_sel_hi:[1,0,1] neg_lo:[0,1,0] neg_hi:[0,1,0]
    v_pk_fma_f32 v[38:39], v[182:183], v[230:231], v[38:39] op_sel_hi:[1,0,1] neg_lo:[0,1,0] neg_hi:[0,1,0]
    v_pk_fma_f32 v[40:41], v[184:185], v[230:231], v[40:41] op_sel_hi:[1,0,1] neg_lo:[0,1,0] neg_hi:[0,1,0]
    v_pk_fma_f32 v[90:91], v[186:187], v[230:231], v[90:91] op_sel_hi:[1,0,1] neg_lo:[0,1,0] neg_hi:[0,1,0]
    v_pk_fma_f32 v[92:93], v[188:189], v[230:231], v[92:93] op_sel_hi:[1,0,1] neg_lo:[0,1,0] neg_hi:[0,1,0]
    v_pk_fma_f32 v[94:95], v[190:191], v[230:231], v[94:95] op_sel_hi:[1,0,1] neg_lo:[0,1,0] neg_hi:[0,1,0]
    v_pk_fma_f32 v[96:97], v[192:193], v[230:231], v[96:97] op_sel_hi:[1,0,1] neg_lo:[0,1,0] neg_hi:[0,1,0]
    s_waitcnt lgkmcnt(0)
    v_mfma_f32_32x32x16_bf16 v[146:161], v[210:213], v[202:205], 0
    v_lshlrev_b32 v178, 16, v194
    v_and_b32 v179, s95, v194
    v_lshlrev_b32 v180, 16, v195
    v_and_b32 v181, s95, v195
    v_lshlrev_b32 v182, 16, v196
    v_and_b32 v183, s95, v196
    v_lshlrev_b32 v184, 16, v197
    v_and_b32 v185, s95, v197
    v_lshlrev_b32 v186, 16, v198
    v_and_b32 v187, s95, v198
    v_lshlrev_b32 v188, 16, v199
    v_and_b32 v189, s95, v199
    v_lshlrev_b32 v190, 16, v200
    v_and_b32 v191, s95, v200
    v_lshlrev_b32 v192, 16, v201
    v_and_b32 v193, s95, v201
    s_add_u32 m0, s93, 4096
    s_nop 0
    buffer_load_dwordx4 v[232:233], s[4:7], s85 idxen offen lds
    buffer_load_dwordx4 v[234:235], s[4:7], s85 idxen offen offset:1024 lds
    ds_read_u16 v232, v240 offset:774
    ds_read_u16 v234, v240 offset:902
    v_pk_fma_f32 v[18:19], v[178:179], v[130:131], v[18:19]
    v_pk_fma_f32 v[20:21], v[180:181], v[132:133], v[20:21]
    v_pk_fma_f32 v[22:23], v[182:183], v[134:135], v[22:23]
    v_pk_fma_f32 v[24:25], v[184:185], v[136:137], v[24:25]
    v_pk_fma_f32 v[74:75], v[186:187], v[138:139], v[74:75]
    v_pk_fma_f32 v[76:77], v[188:189], v[140:141], v[76:77]
    v_pk_fma_f32 v[78:79], v[190:191], v[142:143], v[78:79]
    v_pk_fma_f32 v[80:81], v[192:193], v[144:145], v[80:81]
    v_pk_fma_f32 v[114:115], v[178:179], v[230:231], v[114:115] op_sel_hi:[1,0,1]
    v_pk_fma_f32 v[116:117], v[180:181], v[230:231], v[116:117] op_sel_hi:[1,0,1]
    v_pk_fma_f32 v[118:119], v[182:183], v[230:231], v[118:119] op_sel_hi:[1,0,1]
    v_pk_fma_f32 v[120:121], v[184:185], v[230:231], v[120:121] op_sel_hi:[1,0,1]
    v_pk_fma_f32 v[122:123], v[186:187], v[230:231], v[122:123] op_sel_hi:[1,0,1]
    v_pk_fma_f32 v[124:125], v[188:189], v[230:231], v[124:125] op_sel_hi:[1,0,1]
    v_pk_fma_f32 v[126:127], v[190:191], v[230:231], v[126:127] op_sel_hi:[1,0,1]
    v_pk_fma_f32 v[128:129], v[192:193], v[230:231], v[128:129] op_sel_hi:[1,0,1]
    v_pk_mul_f32 v[178:179], v[178:179], v[162:163]
    v_pk_mul_f32 v[180:181], v[180:181], v[164:165]
    v_pk_mul_f32 v[182:183], v[182:183], v[166:167]
    v_pk_mul_f32 v[184:185], v[184:185], v[168:169]
    v_pk_mul_f32 v[186:187], v[186:187], v[170:171]
    v_pk_mul_f32 v[188:189], v[188:189], v[172:173]
    v_pk_mul_f32 v[190:191], v[190:191], v[174:175]
    v_pk_mul_f32 v[192:193], v[192:193], v[176:177]
    v_pk_fma_f32 v[34:35], v[178:179], v[228:229], v[34:35] op_sel_hi:[1,0,1]
    v_pk_fma_f32 v[36:37], v[180:181], v[228:229], v[36:37] op_sel_hi:[1,0,1]
    v_pk_fma_f32 v[38:39], v[182:183], v[228:229], v[38:39] op_sel_hi:[1,0,1]
    v_pk_fma_f32 v[40:41], v[184:185], v[228:229], v[40:41] op_sel_hi:[1,0,1]
    v_pk_fma_f32 v[90:91], v[186:187], v[228:229], v[90:91] op_sel_hi:[1,0,1]
    v_pk_fma_f32 v[92:93], v[188:189], v[228:229], v[92:93] op_sel_hi:[1,0,1]
    v_pk_fma_f32 v[94:95], v[190:191], v[228:229], v[94:95] op_sel_hi:[1,0,1]
    v_pk_fma_f32 v[96:97], v[192:193], v[228:229], v[96:97] op_sel_hi:[1,0,1]
    s_waitcnt vmcnt(4)
    ds_read_b128 v[194:197], v236 offset:0
    ds_read_b128 v[198:201], v237 offset:0
    v_add_u32 v240, 1024, v240
    v_pk_fma_f32 v[42:43], v[178:179], v[226:227], v[42:43] op_sel_hi:[1,0,1] neg_lo:[0,1,0] neg_hi:[0,1,0]
    v_pk_fma_f32 v[44:45], v[180:181], v[226:227], v[44:45] op_sel_hi:[1,0,1] neg_lo:[0,1,0] neg_hi:[0,1,0]
    v_pk_fma_f32 v[46:47], v[182:183], v[226:227], v[46:47] op_sel_hi:[1,0,1] neg_lo:[0,1,0] neg_hi:[0,1,0]
    v_pk_fma_f32 v[48:49], v[184:185], v[226:227], v[48:49] op_sel_hi:[1,0,1] neg_lo:[0,1,0] neg_hi:[0,1,0]
    v_pk_fma_f32 v[98:99], v[186:187], v[226:227], v[98:99] op_sel_hi:[1,0,1] neg_lo:[0,1,0] neg_hi:[0,1,0]
    v_pk_fma_f32 v[100:101], v[188:189], v[226:227], v[100:101] op_sel_hi:[1,0,1] neg_lo:[0,1,0] neg_hi:[0,1,0]
    v_pk_fma_f32 v[102:103], v[190:191], v[226:227], v[102:103] op_sel_hi:[1,0,1] neg_lo:[0,1,0] neg_hi:[0,1,0]
    v_pk_fma_f32 v[104:105], v[192:193], v[226:227], v[104:105] op_sel_hi:[1,0,1] neg_lo:[0,1,0] neg_hi:[0,1,0]
    v_pk_fma_f32 v[26:27], v[114:115], v[146:147], v[26:27]
    v_pk_fma_f32 v[28:29], v[116:117], v[148:149], v[28:29]
    v_pk_fma_f32 v[30:31], v[118:119], v[150:151], v[30:31]
    v_pk_fma_f32 v[32:33], v[120:121], v[152:153], v[32:33]
    v_pk_fma_f32 v[82:83], v[122:123], v[154:155], v[82:83]
    v_pk_fma_f32 v[84:85], v[124:125], v[156:157], v[84:85]
    v_pk_fma_f32 v[86:87], v[126:127], v[158:159], v[86:87]
    v_pk_fma_f32 v[88:89], v[128:129], v[160:161], v[88:89]
LB_vec_end:
    v_add_u32 v238, s82, v227
    v_add_u32 v239, s81, v229
    ds_read_b128 v[202:205], v238
    s_sub_u32 s91, s92, 1
    v_cvt_pk_bf16_f32 v2, v2, v3
    v_cvt_pk_bf16_f32 v3, v4, v5
    v_cvt_pk_bf16_f32 v4, v6, v7
    v_cvt_pk_bf16_f32 v5, v8, v9
    v_cvt_pk_bf16_f32 v6, v58, v59
    v_cvt_pk_bf16_f32 v7, v60, v61
    v_cvt_pk_bf16_f32 v8, v62, v63
    v_cvt_pk_bf16_f32 v9, v64, v65
    v_cvt_pk_bf16_f32 v10, v10, v11
    v_cvt_pk_bf16_f32 v11, v12, v13
    v_cvt_pk_bf16_f32 v12, v14, v15
    v_cvt_pk_bf16_f32 v13, v16, v17
    v_cvt_pk_bf16_f32 v14, v66, v67
    v_cvt_pk_bf16_f32 v15, v68, v69
    v_cvt_pk_bf16_f32 v16, v70, v71
    v_cvt_pk_bf16_f32 v17, v72, v73
    v_cvt_pk_bf16_f32 v18, v18, v19
    v_cvt_pk_bf16_f32 v19, v20, v21
    v_cvt_pk_bf16_f32 v20, v22, v23
    v_cvt_pk_bf16_f32 v21, v24, v25
    v_cvt_pk_bf16_f32 v22, v74, v75
    v_cvt_pk_bf16_f32 v23, v76, v77
    v_cvt_pk_bf16_f32 v24, v78, v79
    v_cvt_pk_bf16_f32 v25, v80, v81
    v_cvt_pk_bf16_f32 v26, v26, v27
    v_cvt_pk_bf16_f32 v27, v28, v29
    v_cvt_pk_bf16_f32 v28, v30, v31
    v_cvt_pk_bf16_f32 v29, v32, v33
    v_cvt_pk_bf16_f32 v30, v82, v83
    v_cvt_pk_bf16_f32 v31, v84, v85
    v_cvt_pk_bf16_f32 v32, v86, v87
    v_cvt_pk_bf16_f32 v33, v88, v89
    v_cvt_pk_bf16_f32 v34, v34, v35
    v_cvt_pk_bf16_f32 v35, v36, v37
    v_cvt_pk_bf16_f32 v36, v38, v39
    v_cvt_pk_bf16_f32 v37, v40, v41
    v_cvt_pk_bf16_f32 v38, v90, v91
    v_cvt_pk_bf16_f32 v39, v92, v93
    v_cvt_pk_bf16_f32 v40, v94, v95
    v_cvt_pk_bf16_f32 v41, v96, v97
    v_cvt_pk_bf16_f32 v42, v42, v43
    v_cvt_pk_bf16_f32 v43, v44, v45
    v_cvt_pk_bf16_f32 v44, v46, v47
    v_cvt_pk_bf16_f32 v45, v48, v49
    v_cvt_pk_bf16_f32 v46, v98, v99
    v_cvt_pk_bf16_f32 v47, v100, v101
    v_cvt_pk_bf16_f32 v48, v102, v103
    v_cvt_pk_bf16_f32 v49, v104, v105
    v_cvt_pk_bf16_f32 v50, v50, v51
    v_cvt_pk_bf16_f32 v51, v52, v53
    v_cvt_pk_bf16_f32 v52, v54, v55
    v_cvt_pk_bf16_f32 v53, v56, v57
    v_cvt_pk_bf16_f32 v54, v106, v107
    v_cvt_pk_bf16_f32 v55, v108, v109
    v_cvt_pk_bf16_f32 v56, v110, v111
    v_cvt_pk_bf16_f32 v57, v112, v113
    v_permlane16_swap_b32 v26, v30
    v_permlane16_swap_b32 v27, v31
    v_permlane16_swap_b32 v28, v32
    v_permlane16_swap_b32 v29, v33
    v_permlane16_swap_b32 v42, v46
    v_permlane16_swap_b32 v43, v47
    v_permlane16_swap_b32 v44, v48
    v_permlane16_swap_b32 v45, v49
    v_permlane16_swap_b32 v50, v54
    v_permlane16_swap_b32 v51, v55
    v_permlane16_swap_b32 v52, v56
    v_permlane16_swap_b32 v53, v57
    s_lshl_b32 s3, s72, 12
    s_add_u32 s3, s3, 130560
    v_lshl_add_u32 v241, v1, 4, s3
    ds_write_b128 v241, v[30:33] offset:0
    ds_write_b128 v241, v[46:49] offset:1024
    ds_write_b128 v241, v[54:57] offset:2048
    s_setprio 0
    s_waitcnt lgkmcnt(0)
    v_lshlrev_b32 v178, 16, v194
    v_mfma_f32_32x32x16_bf16 v[130:145], v[206:209], v[202:205], 0
    v_and_b32 v179, s95, v194
    v_lshlrev_b32 v180, 16, v195
    v_and_b32 v181, s95, v195
    v_lshlrev_b32 v182, 16, v196
    v_and_b32 v183, s95, v196
    v_lshlrev_b32 v184, 16, v197
    v_mfma_f32_32x32x16_bf16 v[146:161], v[214:217], v[202:205], 0
    v_and_b32 v185, s95, v197
    v_lshlrev_b32 v186, 16, v198
    v_and_b32 v187, s95, v198
    v_lshlrev_b32 v188, 16, v199
    v_and_b32 v189, s95, v199
    v_lshlrev_b32 v190, 16, v200
    v_and_b32 v191, s95, v200
    v_lshlrev_b32 v192, 16, v201
    v_and_b32 v193, s95, v201
    s_cmp_ge_u32 s91, 3
    s_cselect_b32 s6, s6, 0
    s_add_u32 m0, s93, 0
    ds_read_u16_d16_hi v226, v239 offset:0
    ds_read_u16_d16_hi v228, v239 offset:2
    ds_read_u16_d16_hi v230, v239 offset:4
    ds_read_b128 v[202:205], v238 offset:1024
    buffer_load_dwordx4 v[232:233], s[4:7], s85 idxen offen lds
    buffer_load_dwordx4 v[234:235], s[4:7], s85 idxen offen offset:1024 lds
    ds_read_u16 v232, v240 offset:6
    ds_read_u16 v234, v240 offset:134
    v_pk_mul_f32 v[58:59], v[178:179], v[130:131]
    v_pk_mul_f32 v[60:61], v[180:181], v[132:133]
    v_pk_mul_f32 v[62:63], v[182:183], v[134:135]
    v_pk_mul_f32 v[64:65], v[184:185], v[136:137]
    v_pk_mul_f32 v[90:91], v[186:187], v[138:139]
    v_pk_mul_f32 v[92:93], v[188:189], v[140:141]
    v_pk_mul_f32 v[94:95], v[190:191], v[142:143]
    v_pk_mul_f32 v[96:97], v[192:193], v[144:145]
    v_pk_mul_f32 v[178:179], v[178:179], v[146:147]
    v_pk_mul_f32 v[180:181], v[180:181], v[148:149]
    v_pk_mul_f32 v[182:183], v[182:183], v[150:151]
    v_pk_mul_f32 v[184:185], v[184:185], v[152:153]
    v_pk_mul_f32 v[186:187], v[186:187], v[154:155]
    v_pk_mul_f32 v[188:189], v[188:189], v[156:157]
    v_pk_mul_f32 v[190:191], v[190:191], v[158:159]
    v_pk_mul_f32 v[192:193], v[192:193], v[160:161]
    s_waitcnt lgkmcnt(3)
    v_pk_mul_f32 v[66:67], v[178:179], v[226:227] op_sel_hi:[1,0]
    v_pk_mul_f32 v[68:69], v[180:181], v[226:227] op_sel_hi:[1,0]
    v_pk_mul_f32 v[70:71], v[182:183], v[226:227] op_sel_hi:[1,0]
    v_pk_mul_f32 v[72:73], v[184:185], v[226:227] op_sel_hi:[1,0]
    v_pk_mul_f32 v[98:99], v[186:187], v[226:227] op_sel_hi:[1,0]
    v_pk_mul_f32 v[100:101], v[188:189], v[226:227] op_sel_hi:[1,0]
    v_pk_mul_f32 v[102:103], v[190:191], v[226:227] op_sel_hi:[1,0]
    v_pk_mul_f32 v[104:105], v[192:193], v[226:227] op_sel_hi:[1,0]
    s_waitcnt vmcnt(4)
    ds_read_b128 v[194:197], v236 offset:2048
    ds_read_b128 v[198:201], v237 offset:2048
    v_pk_mul_f32 v[74:75], v[178:179], v[228:229] op_sel_hi:[1,0]
    v_pk_mul_f32 v[76:77], v[180:181], v[228:229] op_sel_hi:[1,0]
    v_pk_mul_f32 v[78:79], v[182:183], v[228:229] op_sel_hi:[1,0]
    v_pk_mul_f32 v[80:81], v[184:185], v[228:229] op_sel_hi:[1,0]
    v_pk_mul_f32 v[106:107], v[186:187], v[228:229] op_sel_hi:[1,0]
    v_pk_mul_f32 v[108:109], v[188:189], v[228:229] op_sel_hi:[1,0]
    v_pk_mul_f32 v[110:111], v[190:191], v[228:229] op_sel_hi:[1,0]
    v_pk_mul_f32 v[112:113], v[192:193], v[228:229] op_sel_hi:[1,0]
    v_pk_mul_f32 v[82:83], v[178:179], v[230:231] op_sel_hi:[1,0]
    v_pk_mul_f32 v[84:85], v[180:181], v[230:231] op_sel_hi:[1,0]
    v_pk_mul_f32 v[86:87], v[182:183], v[230:231] op_sel_hi:[1,0]
    v_pk_mul_f32 v[88:89], v[184:185], v[230:231] op_sel_hi:[1,0]
    v_pk_mul_f32 v[114:115], v[186:187], v[230:231] op_sel_hi:[1,0]
    v_pk_mul_f32 v[116:117], v[188:189], v[230:231] op_sel_hi:[1,0]
    v_pk_mul_f32 v[118:119], v[190:191], v[230:231] op_sel_hi:[1,0]
    v_pk_mul_f32 v[120:121], v[192:193], v[230:231] op_sel_hi:[1,0]
    s_sub_u32 s91, s91, 1
    s_branch LB_scal1
LB_scal:
    s_waitcnt lgkmcnt(0)
    v_lshlrev_b32 v178, 16, v194
    v_mfma_f32_32x32x16_bf16 v[130:145], v[206:209], v[202:205], 0
    v_and_b32 v179, s95, v194
    v_lshlrev_b32 v180, 16, v195
    v_and_b32 v181, s95, v195
    v_lshlrev_b32 v182, 16, v196
    v_and_b32 v183, s95, v196
    v_lshlrev_b32 v184, 16, v197
    v_mfma_f32_32x32x16_bf16 v[146:161], v[214:217], v[202:205], 0
    v_and_b32 v185, s95, v197
    v_lshlrev_b32 v186, 16, v198
    v_and_b32 v187, s95, v198
    v_lshlrev_b32 v188, 16, v199
    v_and_b32 v189, s95, v199
    v_lshlrev_b32 v190, 16, v200
    v_and_b32 v191, s95, v200
    v_lshlrev_b32 v192, 16, v201
    v_and_b32 v193, s95, v201
    s_cmp_ge_u32 s91, 3
    s_cselect_b32 s6, s6, 0
    s_add_u32 m0, s93, 0
    ds_read_u16_d16_hi v226, v239 offset:0
    ds_read_u16_d16_hi v228, v239 offset:2
    ds_read_u16_d16_hi v230, v239 offset:4
    ds_read_b128 v[202:205], v238 offset:1024
    buffer_load_dwordx4 v[232:233], s[4:7], s85 idxen offen lds
    buffer_load_dwordx4 v[234:235], s[4:7], s85 idxen offen offset:1024 lds
    ds_read_u16 v232, v240 offset:6
    ds_read_u16 v234, v240 offset:134
    v_pk_fma_f32 v[58:59], v[178:179], v[130:131], v[58:59]
    v_pk_fma_f32 v[60:61], v[180:181], v[132:133], v[60:61]
    v_pk_fma_f32 v[62:63], v[182:183], v[134:135], v[62:63]
    v_pk_fma_f32 v[64:65], v[184:185], v[136:137], v[64:65]
    v_pk_fma_f32 v[90:91], v[186:187], v[138:139], v[90:91]
    v_pk_fma_f32 v[92:93], v[188:189], v[140:141], v[92:93]
    v_pk_fma_f32 v[94:95], v[190:191], v[142:143], v[94:95]
    v_pk_fma_f32 v[96:97], v[192:193], v[144:145], v[96:97]
    v_pk_mul_f32 v[178:179], v[178:179], v[146:147]
    v_pk_mul_f32 v[180:181], v[180:181], v[148:149]
    v_pk_mul_f32 v[182:183], v[182:183], v[150:151]
    v_pk_mul_f32 v[184:185], v[184:185], v[152:153]
    v_pk_mul_f32 v[186:187], v[186:187], v[154:155]
    v_pk_mul_f32 v[188:189], v[188:189], v[156:157]
    v_pk_mul_f32 v[190:191], v[190:191], v[158:159]
    v_pk_mul_f32 v[192:193], v[192:193], v[160:161]
    s_waitcnt lgkmcnt(3)
    v_pk_fma_f32 v[66:67], v[178:179], v[226:227], v[66:67] op_sel_hi:[1,0,1]
    v_pk_fma_f32 v[68:69], v[180:181], v[226:227], v[68:69] op_sel_hi:[1,0,1]
    v_pk_fma_f32 v[70:71], v[182:183], v[226:227], v[70:71] op_sel_hi:[1,0,1]
    v_pk_fma_f32 v[72:73], v[184:185], v[226:227], v[72:73] op_sel_hi:[1,0,1]
    v_pk_fma_f32 v[98:99], v[186:187], v[226:227], v[98:99] op_sel_hi:[1,0,1]
    v_pk_fma_f32 v[100:101], v[188:189], v[226:227], v[100:101] op_sel_hi:[1,0,1]
    v_pk_fma_f32 v[102:103], v[190:191], v[226:227], v[102:103] op_sel_hi:[1,0,1]
    v_pk_fma_f32 v[104:105], v[192:193], v[226:227], v[104:105] op_sel_hi:[1,0,1]
    s_waitcnt vmcnt(4)
    ds_read_b128 v[194:197], v236 offset:2048
    ds_read_b128 v[198:201], v237 offset:2048
    v_pk_fma_f32 v[74:75], v[178:179], v[228:229], v[74:75] op_sel_hi:[1,0,1]
    v_pk_fma_f32 v[76:77], v[180:181], v[228:229], v[76:77] op_sel_hi:[1,0,1]
    v_pk_fma_f32 v[78:79], v[182:183], v[228:229], v[78:79] op_sel_hi:[1,0,1]
    v_pk_fma_f32 v[80:81], v[184:185], v[228:229], v[80:81] op_sel_hi:[1,0,1]
    v_pk_fma_f32 v[106:107], v[186:187], v[228:229], v[106:107] op_sel_hi:[1,0,1]
    v_pk_fma_f32 v[108:109], v[188:189], v[228:229], v[108:109] op_sel_hi:[1,0,1]
    v_pk_fma_f32 v[110:111], v[190:191], v[228:229], v[110:111] op_sel_hi:[1,0,1]
    v_pk_fma_f32 v[112:113], v[192:193], v[228:229], v[112:113] op_sel_hi:[1,0,1]
    v_pk_fma_f32 v[82:83], v[178:179], v[230:231], v[82:83] op_sel_hi:[1,0,1]
    v_pk_fma_f32 v[84:85], v[180:181], v[230:231], v[84:85] op_sel_hi:[1,0,1]
    v_pk_fma_f32 v[86:87], v[182:183], v[230:231], v[86:87] op_sel_hi:[1,0,1]
    v_pk_fma_f32 v[88:89], v[184:185], v[230:231], v[88:89] op_sel_hi:[1,0,1]
    v_pk_fma_f32 v[114:115], v[186:187], v[230:231], v[114:115] op_sel_hi:[1,0,1]
    v_pk_fma_f32 v[116:117], v[188:189], v[230:231], v[116:117] op_sel_hi:[1,0,1]
    v_pk_fma_f32 v[118:119], v[190:191], v[230:231], v[118:119] op_sel_hi:[1,0,1]
    v_pk_fma_f32 v[120:121], v[192:193], v[230:231], v[120:121] op_sel_hi:[1,0,1]
    s_sub_u32 s91, s91, 1
    s_cbranch_scc1 LB_scal_end
LB_scal1:
    s_waitcnt lgkmcnt(0)
    v_lshlrev_b32 v178, 16, v194
    v_mfma_f32_32x32x16_bf16 v[130:145], v[206:209], v[202:205], 0
    v_and_b32 v179, s95, v194
    v_lshlrev_b32 v180, 16, v195
    v_and_b32 v181, s95, v195
    v_lshlrev_b32 v182, 16, v196
    v_and_b32 v183, s95, v196
    v_lshlrev_b32 v184, 16, v197
    v_mfma_f32_32x32x16_bf16 v[146:161], v[214:217], v[202:205], 0
    v_and_b32 v185, s95, v197
    v_lshlrev_b32 v186, 16, v198
    v_and_b32 v187, s95, v198
    v_lshlrev_b32 v188, 16, v199
    v_and_b32 v189, s95, v199
    v_lshlrev_b32 v190, 16, v200
    v_and_b32 v191, s95, v200
    v_lshlrev_b32 v192, 16, v201
    v_and_b32 v193, s95, v201
    s_cmp_ge_u32 s91, 3
    s_cselect_b32 s6, s6, 0
    s_add_u32 m0, s93, 2048
    ds_read_u16_d16_hi v226, v239 offset:256
    ds_read_u16_d16_hi v228, v239 offset:258
    ds_read_u16_d16_hi v230, v239 offset:260
    ds_read_b128 v[202:205], v238 offset:2048
    buffer_load_dwordx4 v[232:233], s[4:7], s85 idxen offen lds
    buffer_load_dwordx4 v[234:235], s[4:7], s85 idxen offen offset:1024 lds
    ds_read_u16 v232, v240 offset:262
    ds_read_u16 v234, v240 offset:390
    v_pk_fma_f32 v[58:59], v[178:179], v[130:131], v[58:59]
    v_pk_fma_f32 v[60:61], v[180:181], v[132:133], v[60:61]
    v_pk_fma_f32 v[62:63], v[182:183], v[134:135], v[62:63]
    v_pk_fma_f32 v[64:65], v[184:185], v[136:137], v[64:65]
    v_pk_fma_f32 v[90:91], v[186:187], v[138:139], v[90:91]
    v_pk_fma_f32 v[92:93], v[188:189], v[140:141], v[92:93]
    v_pk_fma_f32 v[94:95], v[190:191], v[142:143], v[94:95]
    v_pk_fma_f32 v[96:97], v[192:193], v[144:145], v[96:97]
    v_pk_mul_f32 v[178:179], v[178:179], v[146:147]
    v_pk_mul_f32 v[180:181], v[180:181], v[148:149]
    v_pk_mul_f32 v[182:183], v[182:183], v[150:151]
    v_pk_mul_f32 v[184:185], v[184:185], v[152:153]
    v_pk_mul_f32 v[186:187], v[186:187], v[154:155]
    v_pk_mul_f32 v[188:189], v[188:189], v[156:157]
    v_pk_mul_f32 v[190:191], v[190:191], v[158:159]
    v_pk_mul_f32 v[192:193], v[192:193], v[160:161]
    s_waitcnt lgkmcnt(3)
    v_pk_fma_f32 v[66:67], v[178:179], v[226:227], v[66:67] op_sel_hi:[1,0,1]
    v_pk_fma_f32 v[68:69], v[180:181], v[226:227], v[68:69] op_sel_hi:[1,0,1]
    v_pk_fma_f32 v[70:71], v[182:183], v[226:227], v[70:71] op_sel_hi:[1,0,1]
    v_pk_fma_f32 v[72:73], v[184:185], v[226:227], v[72:73] op_sel_hi:[1,0,1]
    v_pk_fma_f32 v[98:99], v[186:187], v[226:227], v[98:99] op_sel_hi:[1,0,1]
    v_pk_fma_f32 v[100:101], v[188:189], v[226:227], v[100:101] op_sel_hi:[1,0,1]
    v_pk_fma_f32 v[102:103], v[190:191], v[226:227], v[102:103] op_sel_hi:[1,0,1]
    v_pk_fma_f32 v[104:105], v[192:193], v[226:227], v[104:105] op_sel_hi:[1,0,1]
    s_waitcnt vmcnt(4)
    ds_read_b128 v[194:197], v236 offset:4096
    ds_read_b128 v[198:201], v237 offset:4096
    v_pk_fma_f32 v[74:75], v[178:179], v[228:229], v[74:75] op_sel_hi:[1,0,1]
    v_pk_fma_f32 v[76:77], v[180:181], v[228:229], v[76:77] op_sel_hi:[1,0,1]
    v_pk_fma_f32 v[78:79], v[182:183], v[228:229], v[78:79] op_sel_hi:[1,0,1]
    v_pk_fma_f32 v[80:81], v[184:185], v[228:229], v[80:81] op_sel_hi:[1,0,1]
    v_pk_fma_f32 v[106:107], v[186:187], v[228:229], v[106:107] op_sel_hi:[1,0,1]
    v_pk_fma_f32 v[108:109], v[188:189], v[228:229], v[108:109] op_sel_hi:[1,0,1]
    v_pk_fma_f32 v[110:111], v[190:191], v[228:229], v[110:111] op_sel_hi:[1,0,1]
    v_pk_fma_f32 v[112:113], v[192:193], v[228:229], v[112:113] op_sel_hi:[1,0,1]
    v_pk_fma_f32 v[82:83], v[178:179], v[230:231], v[82:83] op_sel_hi:[1,0,1]
    v_pk_fma_f32 v[84:85], v[180:181], v[230:231], v[84:85] op_sel_hi:[1,0,1]
    v_pk_fma_f32 v[86:87], v[182:183], v[230:231], v[86:87] op_sel_hi:[1,0,1]
    v_pk_fma_f32 v[88:89], v[184:185], v[230:231], v[88:89] op_sel_hi:[1,0,1]
    v_pk_fma_f32 v[114:115], v[186:187], v[230:231], v[114:115] op_sel_hi:[1,0,1]
    v_pk_fma_f32 v[116:117], v[188:189], v[230:231], v[116:117] op_sel_hi:[1,0,1]
    v_pk_fma_f32 v[118:119], v[190:191], v[230:231], v[118:119] op_sel_hi:[1,0,1]
    v_pk_fma_f32 v[120:121], v[192:193], v[230:231], v[120:121] op_sel_hi:[1,0,1]
    s_sub_u32 s91, s91, 1
    s_cbranch_scc1 LB_scal_end
    s_waitcnt lgkmcnt(0)
    v_lshlrev_b32 v178, 16, v194
    v_mfma_f32_32x32x16_bf16 v[130:145], v[206:209], v[202:205], 0
    v_and_b32 v179, s95, v194
    v_lshlrev_b32 v180, 16, v195
    v_and_b32 v181, s95, v195
    v_lshlrev_b32 v182, 16, v196
    v_and_b32 v183, s95, v196
    v_lshlrev_b32 v184, 16, v197
    v_mfma_f32_32x32x16_bf16 v[146:161], v[214:217], v[202:205], 0
    v_and_b32 v185, s95, v197
    v_lshlrev_b32 v186, 16, v198
    v_and_b32 v187, s95, v198
    v_lshlrev_b32 v188, 16, v199
    v_and_b32 v189, s95, v199
    v_lshlrev_b32 v190, 16, v200
    v_and_b32 v191, s95, v200
    v_lshlrev_b32 v192, 16, v201
    v_and_b32 v193, s95, v201
    s_cmp_ge_u32 s91, 3
    s_cselect_b32 s6, s6, 0
    s_add_u32 m0, s93, 4096
    ds_read_u16_d16_hi v226, v239 offset:512
    ds_read_u16_d16_hi v228, v239 offset:514
    ds_read_u16_d16_hi v230, v239 offset:516
    ds_read_b128 v[202:205], v238 offset:3072
    buffer_load_dwordx4 v[232:233], s[4:7], s85 idxen offen lds
    buffer_load_dwordx4 v[234:235], s[4:7], s85 idxen offen offset:1024 lds
    ds_read_u16 v232, v240 offset:518
    ds_read_u16 v234, v240 offset:646
    v_pk_fma_f32 v[58:59], v[178:179], v[130:131], v[58:59]
    v_pk_fma_f32 v[60:61], v[180:181], v[132:133], v[60:61]
    v_pk_fma_f32 v[62:63], v[182:183], v[134:135], v[62:63]
    v_pk_fma_f32 v[64:65], v[184:185], v[136:137], v[64:65]
    v_pk_fma_f32 v[90:91], v[186:187], v[138:139], v[90:91]
    v_pk_fma_f32 v[92:93], v[188:189], v[140:141], v[92:93]
    v_pk_fma_f32 v[94:95], v[190:191], v[142:143], v[94:95]
    v_pk_fma_f32 v[96:97], v[192:193], v[144:145], v[96:97]
    v_pk_mul_f32 v[178:179], v[178:179], v[146:147]
    v_pk_mul_f32 v[180:181], v[180:181], v[148:149]
    v_pk_mul_f32 v[182:183], v[182:183], v[150:151]
    v_pk_mul_f32 v[184:185], v[184:185], v[152:153]
    v_pk_mul_f32 v[186:187], v[186:187], v[154:155]
    v_pk_mul_f32 v[188:189], v[188:189], v[156:157]
    v_pk_mul_f32 v[190:191], v[190:191], v[158:159]
    v_pk_mul_f32 v[192:193], v[192:193], v[160:161]
    s_waitcnt lgkmcnt(3)
    v_pk_fma_f32 v[66:67], v[178:179], v[226:227], v[66:67] op_sel_hi:[1,0,1]
    v_pk_fma_f32 v[68:69], v[180:181], v[226:227], v[68:69] op_sel_hi:[1,0,1]
    v_pk_fma_f32 v[70:71], v[182:183], v[226:227], v[70:71] op_sel_hi:[1,0,1]
    v_pk_fma_f32 v[72:73], v[184:185], v[226:227], v[72:73] op_sel_hi:[1,0,1]
    v_pk_fma_f32 v[98:99], v[186:187], v[226:227], v[98:99] op_sel_hi:[1,0,1]
    v_pk_fma_f32 v[100:101], v[188:189], v[226:227], v[100:101] op_sel_hi:[1,0,1]
    v_pk_fma_f32 v[102:103], v[190:191], v[226:227], v[102:103] op_sel_hi:[1,0,1]
    v_pk_fma_f32 v[104:105], v[192:193], v[226:227], v[104:105] op_sel_hi:[1,0,1]
    s_waitcnt vmcnt(4)
    ds_read_b128 v[194:197], v236 offset:0
    ds_read_b128 v[198:201], v237 offset:0
    v_add_u32 v238, 3072, v238
    v_add_u32 v239, 768, v239
    v_add_u32 v240, 768, v240
    v_pk_fma_f32 v[74:75], v[178:179], v[228:229], v[74:75] op_sel_hi:[1,0,1]
    v_pk_fma_f32 v[76:77], v[180:181], v[228:229], v[76:77] op_sel_hi:[1,0,1]
    v_pk_fma_f32 v[78:79], v[182:183], v[228:229], v[78:79] op_sel_hi:[1,0,1]
    v_pk_fma_f32 v[80:81], v[184:185], v[228:229], v[80:81] op_sel_hi:[1,0,1]
    v_pk_fma_f32 v[106:107], v[186:187], v[228:229], v[106:107] op_sel_hi:[1,0,1]
    v_pk_fma_f32 v[108:109], v[188:189], v[228:229], v[108:109] op_sel_hi:[1,0,1]
    v_pk_fma_f32 v[110:111], v[190:191], v[228:229], v[110:111] op_sel_hi:[1,0,1]
    v_pk_fma_f32 v[112:113], v[192:193], v[228:229], v[112:113] op_sel_hi:[1,0,1]
    v_pk_fma_f32 v[82:83], v[178:179], v[230:231], v[82:83] op_sel_hi:[1,0,1]
    v_pk_fma_f32 v[84:85], v[180:181], v[230:231], v[84:85] op_sel_hi:[1,0,1]
    v_pk_fma_f32 v[86:87], v[182:183], v[230:231], v[86:87] op_sel_hi:[1,0,1]
    v_pk_fma_f32 v[88:89], v[184:185], v[230:231], v[88:89] op_sel_hi:[1,0,1]
    v_pk_fma_f32 v[114:115], v[186:187], v[230:231], v[114:115] op_sel_hi:[1,0,1]
    v_pk_fma_f32 v[116:117], v[188:189], v[230:231], v[116:117] op_sel_hi:[1,0,1]
    v_pk_fma_f32 v[118:119], v[190:191], v[230:231], v[118:119] op_sel_hi:[1,0,1]
    v_pk_fma_f32 v[120:121], v[192:193], v[230:231], v[120:121] op_sel_hi:[1,0,1]
    s_sub_u32 s91, s91, 1
    s_cbranch_scc0 LB_scal
LB_scal_end:
    s_mul_i32 s3, s72, 5120
    s_add_u32 s3, s3, 16384
    v_lshl_add_u32 v241, v1, 4, s3
    s_mov_b32 m0, s93
    s_waitcnt vmcnt(0) lgkmcnt(0)
    buffer_load_dwordx4 v241, s[12:15], 0 offen offset:0 lds
    buffer_load_dwordx4 v241, s[12:15], 0 offen offset:1024 lds
    buffer_load_dwordx4 v241, s[12:15], 0 offen offset:2048 lds
    buffer_load_dwordx4 v241, s[12:15], 0 offen offset:3072 lds
    s_add_u32 m0, s93, 4096
    v_add_u32 v241, 4096, v241
    buffer_load_dwordx4 v241, s[12:15], 0 offen lds
    v_cvt_pk_bf16_f32 v58, v58, v59
    v_cvt_pk_bf16_f32 v59, v60, v61
    v_cvt_pk_bf16_f32 v60, v62, v63
    v_cvt_pk_bf16_f32 v61, v64, v65
    v_cvt_pk_bf16_f32 v62, v90, v91
    v_cvt_pk_bf16_f32 v63, v92, v93
    v_cvt_pk_bf16_f32 v64, v94, v95
    v_cvt_pk_bf16_f32 v65, v96, v97
    v_cvt_pk_bf16_f32 v66, v66, v67
    v_cvt_pk_bf16_f32 v67, v68, v69
    v_cvt_pk_bf16_f32 v68, v70, v71
    v_cvt_pk_bf16_f32 v69, v72, v73
    v_cvt_pk_bf16_f32 v70, v98, v99
    v_cvt_pk_bf16_f32 v71, v100, v101
    v_cvt_pk_bf16_f32 v72, v102, v103
    v_cvt_pk_bf16_f32 v73, v104, v105
    v_cvt_pk_bf16_f32 v74, v74, v75
    v_cvt_pk_bf16_f32 v75, v76, v77
    v_cvt_pk_bf16_f32 v76, v78, v79
    v_cvt_pk_bf16_f32 v77, v80, v81
    v_cvt_pk_bf16_f32 v78, v106, v107
    v_cvt_pk_bf16_f32 v79, v108, v109
    v_cvt_pk_bf16_f32 v80, v110, v111
    v_cvt_pk_bf16_f32 v81, v112, v113
    v_cvt_pk_bf16_f32 v82, v82, v83
    v_cvt_pk_bf16_f32 v83, v84, v85
    v_cvt_pk_bf16_f32 v84, v86, v87
    v_cvt_pk_bf16_f32 v85, v88, v89
    v_cvt_pk_bf16_f32 v86, v114, v115
    v_cvt_pk_bf16_f32 v87, v116, v117
    v_cvt_pk_bf16_f32 v88, v118, v119
    v_cvt_pk_bf16_f32 v89, v120, v121
    v_permlane16_swap_b32 v58, v62
    v_permlane16_swap_b32 v59, v63
    v_permlane16_swap_b32 v60, v64
    v_permlane16_swap_b32 v61, v65
    s_lshl_b32 s3, s72, 12
    s_add_u32 s3, s3, 130560
    v_lshl_add_u32 v241, v1, 4, s3
    ds_write_b128 v241, v[62:65] offset:3072
LB_epi:
    s_mul_i32 s3, s73, 24576
    v_lshl_add_u32 v238, v1, 4, s3
    s_sub_u32 s3, 24576, s3
    v_lshl_add_u32 v239, v1, 4, s3
    s_bitcmp1_b32 s72, 0
    s_mov_b32 s3, 4096
    s_cselect_b32 s3, -4096, s3
    v_add_u32 v242, s3, v241
    s_mul_i32 s3, s72, 7168
    s_add_u32 s3, s3, 49152
    v_lshl_add_u32 v241, v1, 4, s3
    s_lshl_b32 s3, s80, 9
    s_lshl_b32 s96, s74, 7
    s_add_u32 s3, s3, s96
    s_lshl_b32 s96, s73, 6
    s_add_u32 s3, s3, s96
    s_add_u32 s3, s3, 128512
    v_and_b32 v244, 0x30, v1
    v_add_u32 v244, s3, v244
    ds_read_b128 v[244:247], v244
    s_cmp_eq_u32 s80, 0
    s_cselect_b32 s3, s66, s67
    s_cselect_b32 s94, s68, s69
    s_cselect_b32 s96, s70, s71
    s_and_b32 s94, s94, 1
    s_andn2_b32 s3, 4, s3
    s_or_b32 s94, s94, s3
    s_cmp_eq_u32 s96, 0
    s_cselect_b32 s3, 2, 0
    s_or_b32 s94, s94, s3
    s_cmp_lg_u32 s80, 0
    s_cbranch_scc1 LB_noa
    v_and_b32 v226, 0xfffff, v248
    v_lshrrev_b32 v248, 20, v248
    buffer_load_dwordx2 v[206:207], v226, s[20:23], 0 idxen
    v_and_b32 v228, 0xfffff, v249
    v_lshrrev_b32 v249, 20, v249
    buffer_load_dwordx2 v[208:209], v228, s[20:23], 0 idxen
    v_and_b32 v230, 0xfffff, v250
    v_lshrrev_b32 v250, 20, v250
    buffer_load_dwordx2 v[214:215], v230, s[20:23], 0 idxen
    v_and_b32 v243, 0xfffff, v251
    v_lshrrev_b32 v251, 20, v251
    buffer_load_dwordx2 v[216:217], v243, s[20:23], 0 idxen
    buffer_load_dwordx4 v[90:93], v226, s[8:11], 0 idxen
    buffer_load_dwordx4 v[94:97], v226, s[8:11], 0 idxen offset:16
    buffer_load_dwordx4 v[98:101], v228, s[8:11], 0 idxen
    buffer_load_dwordx4 v[102:105], v228, s[8:11], 0 idxen offset:16
    buffer_load_dwordx4 v[106:109], v230, s[8:11], 0 idxen
    buffer_load_dwordx4 v[110:113], v230, s[8:11], 0 idxen offset:16
    buffer_load_dwordx4 v[114:117], v243, s[8:11], 0 idxen
    buffer_load_dwordx4 v[118:121], v243, s[8:11], 0 idxen offset:16
    s_bitcmp1_b32 s74, 0
    s_cselect_b32 s3, s32, 0
    s_cselect_b32 s96, s33, s32
    s_cselect_b32 s97, s34, s33
    s_cselect_b32 s98, s35, s34
    s_bitcmp1_b32 s74, 1
    s_cselect_b32 s3, s97, s3
    s_cselect_b32 s96, s98, s96
    s_sub_u32 s92, s96, s3
    s_lshl_b32 s82, s3, 10
    s_add_u32 s82, s82, 49152
    s_lshl_b32 s81, s3, 8
    s_add_u32 s81, s81, 112640
    s_sub_u32 s83, 1, s92
    s_lshl_b32 s83, s83, 8
    s_mov_b32 s6, 50000
    v_add_u32 v240, s81, v231
    s_waitcnt vmcnt(12)
    s_branch LB_b1
LB_noa:
    s_waitcnt vmcnt(0)
LB_b1:
    s_waitcnt lgkmcnt(0)
    v_mov_b32 v232, 0x7f000000
    v_cmp_eq_u32 s[36:37], v245, v232
    v_cmp_eq_u32 s[38:39], v247, v232
    v_and_b32 v232, 15, v1
    v_lshl_add_u32 v244, v232, 2, v244
    v_lshl_add_u32 v245, v232, 2, v245
    v_lshl_add_u32 v246, v232, 2, v246
    v_lshl_add_u32 v247, v232, 2, v247
    s_barrier
    s_cmp_eq_u32 s94, 3
    s_cselect_b32 s18, 0x186a000, 0
    s_cbranch_scc0 LB_drain
LB_drained:
    s_mov_b32 s97, 0xbfb8aa3b
    ds_read_b128 v[194:197], v238 offset:0
    ds_read_b128 v[198:201], v238 offset:1024
    ds_read_b128 v[202:205], v238 offset:2048
    ds_read_b128 v[122:125], v238 offset:3072
    ds_read_b128 v[126:129], v238 offset:4096
    ds_read_b128 v[62:65], v242 offset:3072
    ds_read_b128 v[30:33], v242 offset:0
    s_waitcnt lgkmcnt(6)
    v_mfma_f32_16x16x32_bf16 v[130:133], v[58:61], v[194:197], 0
    v_permlane16_swap_b32 v66, v70
    v_permlane16_swap_b32 v67, v71
    ds_read_b128 v[194:197], v238 offset:6144
    s_waitcnt lgkmcnt(6)
    v_mfma_f32_16x16x32_bf16 v[134:137], v[58:61], v[198:201], 0
    v_permlane16_swap_b32 v68, v72
    v_permlane16_swap_b32 v69, v73
    ds_read_b128 v[198:201], v238 offset:7168
    s_waitcnt lgkmcnt(6)
    v_mfma_f32_16x16x32_bf16 v[138:141], v[58:61], v[202:205], 0
    v_permlane16_swap_b32 v74, v78
    v_permlane16_swap_b32 v75, v79
    ds_read_b128 v[202:205], v238 offset:8192
    s_waitcnt lgkmcnt(6)
    v_mfma_f32_16x16x32_bf16 v[142:145], v[58:61], v[122:125], 0
    v_permlane16_swap_b32 v76, v80
    v_permlane16_swap_b32 v77, v81
    ds_read_b128 v[122:125], v239 offset:0
    s_waitcnt lgkmcnt(6)
    v_mfma_f32_16x16x32_bf16 v[130:133], v[26:29], v[126:129], v[130:133]
    v_permlane16_swap_b32 v82, v86
    v_permlane16_swap_b32 v83, v87
    ds_read_b128 v[126:129], v239 offset:1024
    s_waitcnt lgkmcnt(4)
    v_mfma_f32_16x16x32_bf16 v[134:137], v[26:29], v[194:197], v[134:137]
    v_permlane16_swap_b32 v84, v88
    v_permlane16_swap_b32 v85, v89
    ds_read_b128 v[194:197], v239 offset:2048
    s_waitcnt lgkmcnt(4)
    v_mfma_f32_16x16x32_bf16 v[138:141], v[26:29], v[198:201], v[138:141]
    v_permlane16_swap_b32 v2, v6
    v_permlane16_swap_b32 v3, v7
    ds_read_b128 v[198:201], v239 offset:3072
    s_waitcnt lgkmcnt(4)
    v_mfma_f32_16x16x32_bf16 v[142:145], v[26:29], v[202:205], v[142:145]
    v_permlane16_swap_b32 v4, v8
    v_permlane16_swap_b32 v5, v9
    ds_read_b128 v[202:205], v239 offset:4096
    s_waitcnt lgkmcnt(4)
    v_mfma_f32_16x16x32_bf16 v[130:133], v[62:65], v[122:125], v[130:133]
    v_permlane16_swap_b32 v10, v14
    v_permlane16_swap_b32 v11, v15
    ds_read_b128 v[122:125], v239 offset:6144
    s_waitcnt lgkmcnt(4)
    v_mfma_f32_16x16x32_bf16 v[134:137], v[62:65], v[126:129], v[134:137]
    v_permlane16_swap_b32 v12, v16
    v_permlane16_swap_b32 v13, v17
    ds_read_b128 v[126:129], v239 offset:7168
    s_waitcnt lgkmcnt(4)
    v_mfma_f32_16x16x32_bf16 v[138:141], v[62:65], v[194:197], v[138:141]
    v_permlane16_swap_b32 v18, v22
    v_permlane16_swap_b32 v19, v23
    ds_read_b128 v[194:197], v239 offset:8192
    s_waitcnt lgkmcnt(4)
    v_mfma_f32_16x16x32_bf16 v[142:145], v[62:65], v[198:201], v[142:145]
    v_permlane16_swap_b32 v20, v24
    v_permlane16_swap_b32 v21, v25
    ds_read_b128 v[198:201], v238 offset:9216
    s_waitcnt lgkmcnt(4)
    v_mfma_f32_16x16x32_bf16 v[130:133], v[30:33], v[202:205], v[130:133]
    v_permlane16_swap_b32 v34, v38
    v_permlane16_swap_b32 v35, v39
    ds_read_b128 v[202:205], v238 offset:10240
    s_waitcnt lgkmcnt(4)
    v_mfma_f32_16x16x32_bf16 v[134:137], v[30:33], v[122:125], v[134:137]
    v_permlane16_swap_b32 v36, v40
    v_permlane16_swap_b32 v37, v41
    ds_read_b128 v[122:125], v238 offset:12288
    s_waitcnt lgkmcnt(4)
    v_mfma_f32_16x16x32_bf16 v[138:141], v[30:33], v[126:129], v[138:141]
    ds_read_b128 v[126:129], v238 offset:13312
    s_waitcnt lgkmcnt(4)
    v_mfma_f32_16x16x32_bf16 v[142:145], v[30:33], v[194:197], v[142:145]
    ds_read_b128 v[194:197], v238 offset:14336
    s_waitcnt lgkmcnt(4)
    v_mfma_f32_16x16x32_bf16 v[146:149], v[66:69], v[198:201], 0
    v_mfma_f32_16x16x32_bf16 v[162:165], v[74:77], v[198:201], 0
    v_mfma_f32_16x16x32_bf16 v[178:181], v[82:85], v[198:201], 0
    ds_read_b128 v[198:201], v238 offset:15360
    ds_write_b128 v241, v[70:73] offset:0
    s_waitcnt lgkmcnt(5)
    v_mfma_f32_16x16x32_bf16 v[150:153], v[66:69], v[202:205], 0
    v_mfma_f32_16x16x32_bf16 v[166:169], v[74:77], v[202:205], 0
    v_mfma_f32_16x16x32_bf16 v[182:185], v[82:85], v[202:205], 0
    s_mov_b64 exec, s[36:37]
    v_add_f32 v130, v130, v131
    v_add_f32 v134, v134, v135
    v_add_f32 v138, v138, v139
    v_add_f32 v142, v142, v143
    s_mov_b64 exec, s[38:39]
    v_add_f32 v132, v132, v133
    v_add_f32 v136, v136, v137
    v_add_f32 v140, v140, v141
    v_add_f32 v144, v144, v145
    s_mov_b64 exec, -1
    ds_read_b128 v[202:205], v238 offset:16384
    ds_write_b128 v241, v[78:81] offset:1024
    s_waitcnt lgkmcnt(6)
    v_mfma_f32_16x16x32_bf16 v[154:157], v[66:69], v[122:125], 0
    v_mul_f32 v58, s97, v130
    v_mul_f32 v59, s97, v131
    v_mfma_f32_16x16x32_bf16 v[170:173], v[74:77], v[122:125], 0
    v_mul_f32 v60, s97, v132
    v_mul_f32 v61, s97, v133
    v_mfma_f32_16x16x32_bf16 v[186:189], v[82:85], v[122:125], 0
    v_mul_f32 v62, s97, v134
    v_mul_f32 v63, s97, v135
    ds_read_b128 v[122:125], v238 offset:18432
    ds_write_b128 v241, v[86:89] offset:2048
    s_waitcnt lgkmcnt(7)
    v_mfma_f32_16x16x32_bf16 v[158:161], v[66:69], v[126:129], 0
    v_mul_f32 v64, s97, v136
    v_mul_f32 v65, s97, v137
    v_mfma_f32_16x16x32_bf16 v[174:177], v[74:77], v[126:129], 0
    v_mul_f32 v26, s97, v138
    v_mul_f32 v27, s97, v139
    v_mfma_f32_16x16x32_bf16 v[190:193], v[82:85], v[126:129], 0
    v_mul_f32 v28, s97, v140
    v_mul_f32 v29, s97, v141
    ds_read_b128 v[126:129], v238 offset:19456
    ds_write_b128 v241, v[6:9] offset:3072
    s_waitcnt lgkmcnt(8)
    v_mfma_f32_16x16x32_bf16 v[146:149], v[2:5], v[194:197], v[146:149]
    v_mul_f32 v30, s97, v142
    v_mul_f32 v31, s97, v143
    v_mfma_f32_16x16x32_bf16 v[162:165], v[10:13], v[194:197], v[162:165]
    v_mul_f32 v32, s97, v144
    v_mul_f32 v33, s97, v145
    v_mfma_f32_16x16x32_bf16 v[178:181], v[18:21], v[194:197], v[178:181]
    v_cvt_pk_bf16_f32 v66, v130, v134
    v_cvt_pk_bf16_f32 v67, v131, v135
    ds_read_b128 v[194:197], v238 offset:20480
    ds_write_b128 v241, v[14:17] offset:4096
    s_waitcnt lgkmcnt(9)
    v_mfma_f32_16x16x32_bf16 v[150:153], v[2:5], v[198:201], v[150:153]
    v_cvt_pk_bf16_f32 v68, v132, v136
    v_cvt_pk_bf16_f32 v69, v133, v137
    v_mfma_f32_16x16x32_bf16 v[166:169], v[10:13], v[198:201], v[166:169]
    v_cvt_pk_bf16_f32 v82, v138, v142
    v_cvt_pk_bf16_f32 v83, v139, v143
    v_mfma_f32_16x16x32_bf16 v[182:185], v[18:21], v[198:201], v[182:185]
    v_cvt_pk_bf16_f32 v84, v140, v144
    v_cvt_pk_bf16_f32 v85, v141, v145
    ds_read_b128 v[198:201], v238 offset:21504
    ds_write_b128 v241, v[22:25] offset:5120
    s_waitcnt lgkmcnt(9)
    v_mfma_f32_16x16x32_bf16 v[154:157], v[2:5], v[202:205], v[154:157]
    buffer_store_dword v66, v244, s[16:19], 0 offen offset:0 sc1
    buffer_store_dword v67, v245, s[16:19], 0 offen offset:0 sc1
    buffer_store_dword v68, v246, s[16:19], 0 offen offset:0 sc1
    buffer_store_dword v69, v247, s[16:19], 0 offen offset:0 sc1
    buffer_store_dword v82, v244, s[16:19], 0 offen offset:64 sc1
    buffer_store_dword v83, v245, s[16:19], 0 offen offset:64 sc1
    buffer_store_dword v84, v246, s[16:19], 0 offen offset:64 sc1
    buffer_store_dword v85, v247, s[16:19], 0 offen offset:64 sc1
    v_exp_f32 v58, v58
    v_mfma_f32_16x16x32_bf16 v[170:173], v[10:13], v[202:205], v[170:173]
    v_exp_f32 v59, v59
    v_mfma_f32_16x16x32_bf16 v[186:189], v[18:21], v[202:205], v[186:189]
    v_exp_f32 v60, v60
    ds_read_b128 v[202:205], v238 offset:22528
    ds_write_b128 v241, v[38:41] offset:6144
    ds_read_b128 v[46:49], v242 offset:1024
    s_waitcnt lgkmcnt(10)
    v_mfma_f32_16x16x32_bf16 v[158:161], v[2:5], v[122:125], v[158:161]
    v_exp_f32 v61, v61
    v_mfma_f32_16x16x32_bf16 v[174:177], v[10:13], v[122:125], v[174:177]
    v_exp_f32 v62, v62
    v_mfma_f32_16x16x32_bf16 v[190:193], v[18:21], v[122:125], v[190:193]
    v_exp_f32 v63, v63
    ds_read_b128 v[122:125], v239 offset:9216
    s_cmp_lg_u32 s80, 0
    s_cbranch_scc1 L_nowarm_9
    v_mov_b32 v234, 0xffff
    s_waitcnt vmcnt(16)
    v_lshrrev_b32 v232, 16, v207
    v_subrev_u32 v243, 0, v232
    v_cmp_gt_u32 vcc, 3500, v243
    s_nop 1
    v_cndmask_b32 v232, v234, v232, vcc
    v_lshrrev_b32 v228, 16, v209
    v_subrev_u32 v243, 0, v228
    v_cmp_gt_u32 vcc, 3500, v243
    s_nop 1
    v_cndmask_b32 v228, v234, v228, vcc
    v_lshrrev_b32 v230, 16, v215
    v_subrev_u32 v243, 0, v230
    v_cmp_gt_u32 vcc, 3500, v243
    s_nop 1
    v_cndmask_b32 v230, v234, v230, vcc
    buffer_load_dword v253, v232, s[4:7], 0 idxen offset:1152
    buffer_load_dword v253, v232, s[4:7], 0 idxen offset:1280
    buffer_load_dword v253, v232, s[4:7], 0 idxen offset:1408
    buffer_load_dword v253, v228, s[4:7], 0 idxen offset:1152
    buffer_load_dword v253, v228, s[4:7], 0 idxen offset:1280
    buffer_load_dword v253, v228, s[4:7], 0 idxen offset:1408
    buffer_load_dword v253, v230, s[4:7], 0 idxen offset:1152
    buffer_load_dword v253, v230, s[4:7], 0 idxen offset:1280
    buffer_load_dword v253, v230, s[4:7], 0 idxen offset:1408
L_nowarm_9:
    ds_read_b128 v[54:57], v242 offset:2048
    s_waitcnt lgkmcnt(10)
    v_mfma_f32_16x16x32_bf16 v[146:149], v[34:37], v[126:129], v[146:149]
    v_exp_f32 v64, v64
    v_mfma_f32_16x16x32_bf16 v[162:165], v[42:45], v[126:129], v[162:165]
    v_exp_f32 v65, v65
    v_mfma_f32_16x16x32_bf16 v[178:181], v[50:53], v[126:129], v[178:181]
    v_exp_f32 v26, v26
    ds_read_b128 v[126:129], v239 offset:14336
    v_and_b32 v18, 0x1fc, v0
    v_add_u32 v18, 130048, v18
    ds_read_b32 v18, v18
    s_bitcmp1_b32 s72, 0
    s_mov_b32 s3, 7168
    s_cselect_b32 s3, -7168, s3
    v_add_u32 v241, s3, v241
    s_waitcnt lgkmcnt(5)
    s_barrier
    ds_read_b128 v[70:73], v241 offset:0
    ds_read_b128 v[78:81], v241 offset:1024
    ds_read_b128 v[86:89], v241 offset:2048
    ds_read_b128 v[6:9], v241 offset:3072
    v_mfma_f32_16x16x32_bf16 v[150:153], v[34:37], v[194:197], v[150:153]
    v_exp_f32 v27, v27
    v_mfma_f32_16x16x32_bf16 v[166:169], v[42:45], v[194:197], v[166:169]
    v_exp_f32 v28, v28
    v_mfma_f32_16x16x32_bf16 v[182:185], v[50:53], v[194:197], v[182:185]
    v_exp_f32 v29, v29
    ds_read_b128 v[194:197], v239 offset:19456
    ds_read_b128 v[14:17], v241 offset:4096
    ds_read_b128 v[22:25], v241 offset:5120
    v_mfma_f32_16x16x32_bf16 v[154:157], v[34:37], v[198:201], v[154:157]
    v_exp_f32 v30, v30
    v_mfma_f32_16x16x32_bf16 v[170:173], v[42:45], v[198:201], v[170:173]
    v_exp_f32 v31, v31
    v_mfma_f32_16x16x32_bf16 v[186:189], v[50:53], v[198:201], v[186:189]
    v_exp_f32 v32, v32
    ds_read_b128 v[198:201], v239 offset:10240
    ds_read_b128 v[38:41], v241 offset:6144
    v_mfma_f32_16x16x32_bf16 v[158:161], v[34:37], v[202:205], v[158:161]
    v_exp_f32 v33, v33
    v_mfma_f32_16x16x32_bf16 v[174:177], v[42:45], v[202:205], v[174:177]
    v_add_f32 v58, 1.0, v58
    v_add_f32 v59, 1.0, v59
    v_mfma_f32_16x16x32_bf16 v[190:193], v[50:53], v[202:205], v[190:193]
    v_add_f32 v60, 1.0, v60
    v_add_f32 v61, 1.0, v61
    ds_read_b128 v[202:205], v239 offset:15360
    s_waitcnt lgkmcnt(7)
    v_mfma_f32_16x16x32_bf16 v[146:149], v[70:73], v[122:125], v[146:149]
    v_add_f32 v62, 1.0, v62
    v_add_f32 v63, 1.0, v63
    v_mfma_f32_16x16x32_bf16 v[162:165], v[78:81], v[122:125], v[162:165]
    v_add_f32 v64, 1.0, v64
    v_add_f32 v65, 1.0, v65
    v_mfma_f32_16x16x32_bf16 v[178:181], v[86:89], v[122:125], v[178:181]
    v_add_f32 v26, 1.0, v26
    v_add_f32 v27, 1.0, v27
    ds_read_b128 v[122:125], v239 offset:20480
    s_waitcnt lgkmcnt(4)
    v_mfma_f32_16x16x32_bf16 v[146:149], v[6:9], v[126:129], v[146:149]
    v_add_f32 v28, 1.0, v28
    v_add_f32 v29, 1.0, v29
    v_mfma_f32_16x16x32_bf16 v[162:165], v[14:17], v[126:129], v[162:165]
    v_add_f32 v30, 1.0, v30
    v_add_f32 v31, 1.0, v31
    v_mfma_f32_16x16x32_bf16 v[178:181], v[22:25], v[126:129], v[178:181]
    v_add_f32 v32, 1.0, v32
    v_add_f32 v33, 1.0, v33
    ds_read_b128 v[126:129], v239 offset:12288
    s_cmp_lg_u32 s80, 0
    s_cbranch_scc1 LB_nometa
    v_mov_b32 v74, 0xc4000000
    v_mov_b32 v75, 0xc4000000
    v_and_b32 v19, 3, v0
    v_add_u32 v19, v18, v19
    v_lshrrev_b32 v20, 16, v19
    v_and_b32 v19, 0xffff, v19
    v_sub_u32 v20, v20, v19
    s_mov_b32 s3, 112640
    v_lshl_add_u32 v19, v19, 8, s3
    v_and_b32 v21, 0x78, v0
    v_add_u32 v19, v21, v19
    v_and_b32 v21, 4, v0
    v_lshl_add_u32 v19, v21, 5, v19
LB_mz:
    v_cmpx_lt_i32 vcc, 0, v20
    ds_write_b64 v19, v[74:75]
    v_cmpx_lt_i32 vcc, 4, v20
    v_add_u32 v19, 1024, v19
    v_subrev_u32 v20, 4, v20
    s_cbranch_execnz LB_mz
    s_mov_b64 exec, -1
    v_lshl_add_u32 v243, v248, 3, s3
    s_mov_b64 exec, s[46:47]
    ds_write_b64 v243, v[206:207]
    s_mov_b64 exec, -1
    v_lshl_add_u32 v243, v249, 3, s3
    s_mov_b64 exec, s[48:49]
    ds_write_b64 v243, v[208:209]
    s_mov_b64 exec, -1
    v_lshl_add_u32 v243, v250, 3, s3
    s_mov_b64 exec, s[50:51]
    ds_write_b64 v243, v[214:215]
    s_mov_b64 exec, -1
    v_lshl_add_u32 v243, v251, 3, s3
    s_mov_b64 exec, s[52:53]
    ds_write_b64 v243, v[216:217]
    s_mov_b64 exec, -1
    s_cmpk_gt_u32 s76, 256
    s_cbranch_scc1 L_rare_10
L_rback_11:
    s_lshl_b32 s3, s73, 10
    s_add_u32 s3, s3, 0
    v_lshl_add_u32 v243, v1, 4, s3
    buffer_load_dwordx4 v[206:209], v243, s[12:15], 0 offen
    v_add_u32 v243, 4096, v243
    buffer_load_dwordx4 v[214:217], v243, s[12:15], 0 offen
LB_nometa:
    s_waitcnt lgkmcnt(3)
    v_mfma_f32_16x16x32_bf16 v[146:149], v[38:41], v[194:197], v[146:149]
    v_rcp_f32 v58, v58
    v_mfma_f32_16x16x32_bf16 v[162:165], v[46:49], v[194:197], v[162:165]
    v_rcp_f32 v59, v59
    v_mfma_f32_16x16x32_bf16 v[178:181], v[54:57], v[194:197], v[178:181]
    v_rcp_f32 v60, v60
    ds_read_b128 v[194:197], v239 offset:16384
    v_mfma_f32_16x16x32_bf16 v[150:153], v[70:73], v[198:201], v[150:153]
    v_rcp_f32 v61, v61
    v_mfma_f32_16x16x32_bf16 v[166:169], v[78:81], v[198:201], v[166:169]
    v_rcp_f32 v62, v62
    v_mfma_f32_16x16x32_bf16 v[182:185], v[86:89], v[198:201], v[182:185]
    v_rcp_f32 v63, v63
    ds_read_b128 v[198:201], v239 offset:21504
    s_waitcnt lgkmcnt(4)
    v_mfma_f32_16x16x32_bf16 v[150:153], v[6:9], v[202:205], v[150:153]
    v_rcp_f32 v64, v64
    v_mfma_f32_16x16x32_bf16 v[166:169], v[14:17], v[202:205], v[166:169]
    v_rcp_f32 v65, v65
    v_mfma_f32_16x16x32_bf16 v[182:185], v[22:25], v[202:205], v[182:185]
    v_rcp_f32 v26, v26
    ds_read_b128 v[202:205], v239 offset:13312
    s_waitcnt lgkmcnt(4)
    v_mfma_f32_16x16x32_bf16 v[150:153], v[38:41], v[122:125], v[150:153]
    v_rcp_f32 v27, v27
    v_mfma_f32_16x16x32_bf16 v[166:169], v[46:49], v[122:125], v[166:169]
    v_rcp_f32 v28, v28
    v_mfma_f32_16x16x32_bf16 v[182:185], v[54:57], v[122:125], v[182:185]
    v_rcp_f32 v29, v29
    ds_read_b128 v[122:125], v239 offset:18432
    s_waitcnt lgkmcnt(4)
    v_mfma_f32_16x16x32_bf16 v[154:157], v[70:73], v[126:129], v[154:157]
    v_rcp_f32 v30, v30
    v_mfma_f32_16x16x32_bf16 v[170:173], v[78:81], v[126:129], v[170:173]
    v_rcp_f32 v31, v31
    v_mfma_f32_16x16x32_bf16 v[186:189], v[86:89], v[126:129], v[186:189]
    v_rcp_f32 v32, v32
    ds_read_b128 v[126:129], v239 offset:22528
    s_waitcnt lgkmcnt(4)
    v_mfma_f32_16x16x32_bf16 v[154:157], v[6:9], v[194:197], v[154:157]
    v_rcp_f32 v33, v33
    v_mfma_f32_16x16x32_bf16 v[170:173], v[14:17], v[194:197], v[170:173]
    v_mfma_f32_16x16x32_bf16 v[186:189], v[22:25], v[194:197], v[186:189]
    s_mov_b64 exec, s[36:37]
    v_add_f32 v146, v146, v147
    v_add_f32 v150, v150, v151
    v_add_f32 v162, v162, v163
    v_add_f32 v166, v166, v167
    v_add_f32 v178, v178, v179
    v_add_f32 v182, v182, v183
    s_mov_b64 exec, s[38:39]
    v_add_f32 v148, v148, v149
    v_add_f32 v152, v152, v153
    v_add_f32 v164, v164, v165
    v_add_f32 v168, v168, v169
    v_add_f32 v180, v180, v181
    v_add_f32 v184, v184, v185
    s_mov_b64 exec, -1
    s_waitcnt lgkmcnt(3)
    v_mfma_f32_16x16x32_bf16 v[154:157], v[38:41], v[198:201], v[154:157]
    v_mul_f32 v2, v146, v58
    v_mul_f32 v3, v147, v59
    v_mfma_f32_16x16x32_bf16 v[170:173], v[46:49], v[198:201], v[170:173]
    v_mul_f32 v4, v148, v60
    v_mul_f32 v5, v149, v61
    v_mfma_f32_16x16x32_bf16 v[186:189], v[54:57], v[198:201], v[186:189]
    v_mul_f32 v10, v150, v62
    v_mul_f32 v11, v151, v63
    s_waitcnt lgkmcnt(2)
    v_mfma_f32_16x16x32_bf16 v[158:161], v[70:73], v[202:205], v[158:161]
    v_mul_f32 v12, v152, v64
    v_mul_f32 v13, v153, v65
    v_mfma_f32_16x16x32_bf16 v[174:177], v[78:81], v[202:205], v[174:177]
    v_cvt_pk_bf16_f32 v34, v2, v10
    v_cvt_pk_bf16_f32 v35, v3, v11
    v_mfma_f32_16x16x32_bf16 v[190:193], v[86:89], v[202:205], v[190:193]
    v_cvt_pk_bf16_f32 v36, v4, v12
    v_cvt_pk_bf16_f32 v37, v5, v13
    s_waitcnt lgkmcnt(1)
    v_mfma_f32_16x16x32_bf16 v[158:161], v[6:9], v[122:125], v[158:161]
    buffer_store_dword v34, v244, s[16:19], 0 offen offset:128 sc1
    buffer_store_dword v35, v245, s[16:19], 0 offen offset:128 sc1
    buffer_store_dword v36, v246, s[16:19], 0 offen offset:128 sc1
    buffer_store_dword v37, v247, s[16:19], 0 offen offset:128 sc1
    v_mul_f32 v2, v162, v58
    v_mul_f32 v3, v163, v59
    v_mfma_f32_16x16x32_bf16 v[174:177], v[14:17], v[122:125], v[174:177]
    v_mul_f32 v4, v164, v60
    v_mul_f32 v5, v165, v61
    v_mfma_f32_16x16x32_bf16 v[190:193], v[22:25], v[122:125], v[190:193]
    v_mul_f32 v10, v166, v62
    v_mul_f32 v11, v167, v63
    s_waitcnt lgkmcnt(0)
    v_mfma_f32_16x16x32_bf16 v[158:161], v[38:41], v[126:129], v[158:161]
    v_mul_f32 v12, v168, v64
    v_mul_f32 v13, v169, v65
    v_mfma_f32_16x16x32_bf16 v[174:177], v[46:49], v[126:129], v[174:177]
    v_cvt_pk_bf16_f32 v42, v2, v10
    v_cvt_pk_bf16_f32 v43, v3, v11
    v_mfma_f32_16x16x32_bf16 v[190:193], v[54:57], v[126:129], v[190:193]
    v_cvt_pk_bf16_f32 v44, v4, v12
    v_cvt_pk_bf16_f32 v45, v5, v13
    buffer_store_dword v42, v244, s[16:19], 0 offen offset:256 sc1
    buffer_store_dword v43, v245, s[16:19], 0 offen offset:256 sc1
    buffer_store_dword v44, v246, s[16:19], 0 offen offset:256 sc1
    buffer_store_dword v45, v247, s[16:19], 0 offen offset:256 sc1
    v_mul_f32 v2, v178, v58
    v_mul_f32 v3, v179, v59
    v_mul_f32 v4, v180, v60
    v_mul_f32 v5, v181, v61
    v_mul_f32 v10, v182, v62
    v_mul_f32 v11, v183, v63
    v_mul_f32 v12, v184, v64
    v_mul_f32 v13, v185, v65
    v_cvt_pk_bf16_f32 v50, v2, v10
    v_cvt_pk_bf16_f32 v51, v3, v11
    v_cvt_pk_bf16_f32 v52, v4, v12
    v_cvt_pk_bf16_f32 v53, v5, v13
    buffer_store_dword v50, v244, s[16:19], 0 offen offset:384 sc1
    buffer_store_dword v51, v245, s[16:19], 0 offen offset:384 sc1
    buffer_store_dword v52, v246, s[16:19], 0 offen offset:384 sc1
    buffer_store_dword v53, v247, s[16:19], 0 offen offset:384 sc1
    s_cmp_lg_u32 s80, 0
    s_cbranch_scc1 LB_post
    s_barrier
    s_waitcnt vmcnt(31)
    ds_read_u16 v232, v240 offset:6
    ds_read_u16 v234, v240 offset:134
    v_add_u32 v240, 256, v240
    s_waitcnt lgkmcnt(0)
    s_add_u32 m0, s93, 0
    s_nop 0
    buffer_load_dwordx4 v[232:233], s[4:7], s86 idxen offen lds
    buffer_load_dwordx4 v[234:235], s[4:7], s86 idxen offen offset:1024 lds
    s_add_u32 m0, s93, 2048
    s_nop 0
    buffer_load_dwordx4 v[232:233], s[4:7], s87 idxen offen lds
    buffer_load_dwordx4 v[234:235], s[4:7], s87 idxen offen offset:1024 lds
    s_add_u32 m0, s93, 4096
    s_nop 0
    buffer_load_dwordx4 v[232:233], s[4:7], s88 idxen offen lds
    buffer_load_dwordx4 v[234:235], s[4:7], s88 idxen offen offset:1024 lds
    ds_read_u16 v232, v240 offset:6
    ds_read_u16 v234, v240 offset:134
LB_noprime:
    v_lshlrev_b32 v66, 5, v248
    v_and_or_b32 v66, v248, 16, v66
    v_xor_b32 v248, 16, v66
    v_lshlrev_b32 v67, 5, v249
    v_and_or_b32 v67, v249, 16, v67
    v_xor_b32 v249, 16, v67
    v_lshlrev_b32 v68, 5, v250
    v_and_or_b32 v68, v250, 16, v68
    v_xor_b32 v250, 16, v68
    v_lshlrev_b32 v69, 5, v251
    v_and_or_b32 v69, v251, 16, v69
    v_xor_b32 v251, 16, v69
    s_mov_b64 exec, s[46:47]
    ds_write_b128 v66, v[90:93] offset:49152
    ds_write_b128 v248, v[94:97] offset:49152
    s_mov_b64 exec, s[48:49]
    ds_write_b128 v67, v[98:101] offset:49152
    ds_write_b128 v249, v[102:105] offset:49152
    s_mov_b64 exec, s[50:51]
    ds_write_b128 v68, v[106:109] offset:49152
    ds_write_b128 v250, v[110:113] offset:49152
    s_mov_b64 exec, s[52:53]
    ds_write_b128 v69, v[114:117] offset:49152
    ds_write_b128 v251, v[118:121] offset:49152
    s_mov_b64 exec, -1
    s_cmpk_gt_u32 s76, 256
    s_cbranch_scc1 L_rare_12
L_rback_13:
    v_mov_b32 v74, 0
    v_mov_b32 v75, 0
    v_mov_b32 v76, 0
    v_mov_b32 v77, 0
    v_bfe_u32 v19, v0, 1, 1
    v_add_u32 v18, v18, v19
    v_lshrrev_b32 v19, 16, v18
    v_and_b32 v18, 0xffff, v18
    v_sub_u32 v19, v19, v18
    v_lshlrev_b32 v18, 10, v18
    v_and_b32 v20, 0x78, v0
    v_lshl_add_u32 v18, v20, 2, v18
    v_and_b32 v20, 4, v0
    v_lshl_add_u32 v18, v20, 7, v18
    v_and_b32 v20, 1, v0
    v_lshl_add_u32 v18, v20, 4, v18
L_zero_14:
    v_cmpx_lt_i32 vcc, 0, v19
    ds_write_b128 v18, v[74:77] offset:49152
    v_cmpx_lt_i32 vcc, 2, v19
    ds_write_b128 v18, v[74:77] offset:51200
    v_add_u32 v18, 4096, v18
    v_subrev_u32 v19, 4, v19
    s_cbranch_execnz L_zero_14
    s_mov_b64 exec, -1
LB_post:
    s_or_b64 s[56:57], s[36:37], s[38:39]
    s_cbranch_scc0 LB_nofold
    s_mov_b64 exec, s[36:37]
    v_add_f32 v154, v154, v155
    v_add_f32 v158, v158, v159
    v_add_f32 v170, v170, v171
    v_add_f32 v174, v174, v175
    v_add_f32 v186, v186, v187
    v_add_f32 v190, v190, v191
    s_mov_b64 exec, s[38:39]
    v_add_f32 v156, v156, v157
    v_add_f32 v160, v160, v161
    v_add_f32 v172, v172, v173
    v_add_f32 v176, v176, v177
    v_add_f32 v188, v188, v189
    v_add_f32 v192, v192, v193
    s_mov_b64 exec, -1
LB_nofold:
    s_cmp_lg_u32 s94, 3
    s_cbranch_scc1 LB_multi
LB_gate:
    v_pk_mul_f32 v[154:155], v[154:155], v[26:27]
    v_pk_mul_f32 v[156:157], v[156:157], v[28:29]
    v_pk_mul_f32 v[158:159], v[158:159], v[30:31]
    v_pk_mul_f32 v[160:161], v[160:161], v[32:33]
    v_cvt_pk_bf16_f32 v38, v154, v158
    v_cvt_pk_bf16_f32 v39, v155, v159
    v_cvt_pk_bf16_f32 v40, v156, v160
    v_cvt_pk_bf16_f32 v41, v157, v161
    buffer_store_dword v38, v244, s[16:19], 0 offen offset:192 sc1
    buffer_store_dword v39, v245, s[16:19], 0 offen offset:192 sc1
    buffer_store_dword v40, v246, s[16:19], 0 offen offset:192 sc1
    buffer_store_dword v41, v247, s[16:19], 0 offen offset:192 sc1
    v_pk_mul_f32 v[170:171], v[170:171], v[26:27]
    v_pk_mul_f32 v[172:173], v[172:173], v[28:29]
    v_pk_mul_f32 v[174:175], v[174:175], v[30:31]
    v_pk_mul_f32 v[176:177], v[176:177], v[32:33]
    v_cvt_pk_bf16_f32 v46, v170, v174
    v_cvt_pk_bf16_f32 v47, v171, v175
    v_cvt_pk_bf16_f32 v48, v172, v176
    v_cvt_pk_bf16_f32 v49, v173, v177
    buffer_store_dword v46, v244, s[16:19], 0 offen offset:320 sc1
    buffer_store_dword v47, v245, s[16:19], 0 offen offset:320 sc1
    buffer_store_dword v48, v246, s[16:19], 0 offen offset:320 sc1
    buffer_store_dword v49, v247, s[16:19], 0 offen offset:320 sc1
    v_pk_mul_f32 v[186:187], v[186:187], v[26:27]
    v_pk_mul_f32 v[188:189], v[188:189], v[28:29]
    v_pk_mul_f32 v[190:191], v[190:191], v[30:31]
    v_pk_mul_f32 v[192:193], v[192:193], v[32:33]
    v_cvt_pk_bf16_f32 v54, v186, v190
    v_cvt_pk_bf16_f32 v55, v187, v191
    v_cvt_pk_bf16_f32 v56, v188, v192
    v_cvt_pk_bf16_f32 v57, v189, v193
    buffer_store_dword v54, v244, s[16:19], 0 offen offset:448 sc1
    buffer_store_dword v55, v245, s[16:19], 0 offen offset:448 sc1
    buffer_store_dword v56, v246, s[16:19], 0 offen offset:448 sc1
    buffer_store_dword v57, v247, s[16:19], 0 offen offset:448 sc1
LB_round_end:
    s_cmp_lg_u32 s80, 0
    s_cbranch_scc1 LB_jobdone
    s_mov_b32 s80, 1
    s_waitcnt vmcnt(16) lgkmcnt(0)
    s_barrier
    s_branch LB_round
LB_jobdone:
    s_or_b32 s3, s70, s71
    s_cbranch_scc0 LB_end
    s_add_u32 s60, s60, s62
    s_cmp_lg_u32 s70, 0
    s_cselect_b32 s66, -1, 0
    s_add_u32 s61, s61, s63
    s_cmp_lg_u32 s71, 0
    s_cselect_b32 s67, -1, 0
    s_mov_b64 s[68:69], 0
    s_branch LB_again
LB_shrink:
    s_add_u32 s3, s64, 1
    s_lshr_b32 s3, s3, 1
    s_cmp_gt_u32 s31, 62
    s_cselect_b32 s64, s3, s64
    s_add_u32 s3, s65, 1
    s_lshr_b32 s3, s3, 1
    s_cmp_gt_u32 s35, 62
    s_cselect_b32 s65, s3, s65
LB_again:
    s_waitcnt vmcnt(0) lgkmcnt(0)
    s_barrier
    s_mul_i32 s96, s72, 2560
    s_add_u32 s96, s96, 20480
    v_lshl_add_u32 v61, v1, 4, s96
    v_mov_b32 v2, 0xfffff
    v_mov_b32 v3, 0xfffff
    v_mov_b32 v4, 0xfffff
    v_mov_b32 v5, 0xfffff
    ds_write_b128 v61, v[2:5] offset:0
    ds_write_b128 v61, v[2:5] offset:1024
    ds_write_b128 v61, v[2:5] offset:1536
    v_mov_b64 v[72:73], 0
    v_mov_b64 v[74:75], 0
    v_and_b32 v60, 0xff, v0
    v_cmp_gt_u32 vcc, 34, v60
    v_lshl_add_u32 v60, v60, 4, s79
    ds_write_b128 v60, v[72:75]
    s_mov_b64 exec, vcc
    ds_write_b128 v60, v[72:75] offset:4096
    s_mov_b64 exec, -1
    s_and_b32 s3, s78, 255
    s_lshl_b32 s3, s3, 3
    s_lshl_b32 s97, s72, 11
    s_add_u32 s3, s3, s97
    s_add_u32 s3, s3, 65536
    v_lshl_add_u32 v59, v1, 14, s3
    s_mov_b32 s14, 577536
    buffer_load_dwordx2 v[50:51], v59, s[12:15], 0 offen
    s_mov_b32 s14, 0x10000000
    s_branch LB_job
LB_drain:
    s_waitcnt vmcnt(0)
    s_branch LB_drained
LB_more:
    v_mov_b32 v59, 0
    v_mov_b32 v60, s70
    ds_max_u32 v59, v60 offset:4624
    v_mov_b32 v60, s71
    ds_max_u32 v59, v60 offset:4628
    s_branch LB_more_back
L_rare_1:
    ds_read_b32 v14, v58 offset:1024
    ds_read_b32 v19, v58 offset:2304
    s_waitcnt lgkmcnt(0)
    v_add_u32 v14, v14, v65
    v_cmp_gt_u32 s[44:45], s26, v14
    buffer_load_ushort v24, v14, s[24:27], 0 idxen
    v_add_u32 v19, v19, v65
    v_cmp_gt_u32 s[54:55], s26, v19
    buffer_load_ushort v29, v19, s[24:27], 0 idxen
    s_waitcnt vmcnt(0)
    s_mov_b64 exec, s[44:45]
    ds_add_rtn_u32 v34, v24, v55 offset:0
    s_mov_b64 exec, s[54:55]
    ds_add_rtn_u32 v39, v29, v55 offset:9856
    s_mov_b64 exec, -1
    s_branch L_rback_2
L_rare_3:
    v_lshrrev_b32 v44, 3, v24
    v_and_b32 v44, 0x1fc, v44
    ds_read_b32 v44, v44 offset:5248
    v_lshrrev_b32 v49, 3, v29
    v_and_b32 v49, 0x1fc, v49
    ds_read_b32 v49, v49 offset:15104
    ds_read_b32 v24, v24 offset:5760
    ds_read_b32 v29, v29 offset:15616
    buffer_load_dwordx2 v[2:3], v14, s[20:23], 0 idxen
    s_waitcnt vmcnt(0) lgkmcnt(0)
    v_add_u32 v34, v34, v24
    v_bfe_u32 v59, v44, 11, 7
    v_cmp_ge_u32 vcc, v34, v59
    v_bfe_u32 v59, v44, 18, 7
    v_lshrrev_b32 v24, 26, v44
    v_cndmask_b32 v59, 0, v59, vcc
    v_add_u32 v34, v34, v59
    v_mad_u32_u24 v44, v34, v24, v44
    v_and_b32 v44, 0x7ff, v44
    v_add_u32 v39, v39, v29
    v_bfe_u32 v59, v49, 11, 7
    v_cmp_ge_u32 vcc, v39, v59
    v_bfe_u32 v59, v49, 18, 7
    v_lshrrev_b32 v29, 26, v49
    v_cndmask_b32 v59, 0, v59, vcc
    v_add_u32 v39, v39, v59
    v_mad_u32_u24 v49, v39, v29, v49
    v_and_b32 v49, 0x7ff, v49
    v_lshl_add_u32 v34, v44, 3, s3
    s_mov_b64 exec, s[44:45]
    ds_write_b64 v34, v[2:3]
    s_mov_b64 exec, -1
    v_lshl_or_b32 v49, v49, 20, v19
    v_cndmask_b32 v252, -1, v49, s[54:55]
    s_branch L_rback_4
L_rare_5:
    buffer_load_dwordx4 v[90:93], v14, s[8:11], 0 idxen
    buffer_load_dwordx4 v[94:97], v14, s[8:11], 0 idxen offset:16
    s_waitcnt vmcnt(0)
    v_lshlrev_b32 v59, 5, v44
    v_and_or_b32 v59, v44, 16, v59
    v_xor_b32 v44, 16, v59
    s_mov_b64 exec, s[44:45]
    ds_write_b128 v59, v[90:93] offset:49152
    ds_write_b128 v44, v[94:97] offset:49152
    s_mov_b64 exec, -1
    s_branch L_rback_6
L_rare_10:
    v_and_b32 v226, 0xfffff, v252
    v_lshrrev_b32 v252, 20, v252
    buffer_load_dwordx2 v[206:207], v226, s[20:23], 0 idxen
    s_waitcnt vmcnt(0)
    v_lshl_add_u32 v243, v252, 3, s3
    s_mov_b64 exec, s[54:55]
    ds_write_b64 v243, v[206:207]
    s_mov_b64 exec, -1
    s_branch L_rback_11
L_rare_12:
    buffer_load_dwordx4 v[90:93], v226, s[8:11], 0 idxen
    buffer_load_dwordx4 v[94:97], v226, s[8:11], 0 idxen offset:16
    s_waitcnt vmcnt(0)
    v_lshlrev_b32 v243, 5, v252
    v_and_or_b32 v243, v252, 16, v243
    v_xor_b32 v252, 16, v243
    s_mov_b64 exec, s[54:55]
    ds_write_b128 v243, v[90:93] offset:49152
    ds_write_b128 v252, v[94:97] offset:49152
    s_mov_b64 exec, -1
    s_branch L_rback_13
LB_multi:
    s_waitcnt vmcnt(0)
    s_bitcmp1_b32 s94, 2
    s_cbranch_scc1 LB_round_end
    s_add_u32 s24, s12, 0x4000000
    s_addc_u32 s25, s13, 0
    s_mov_b32 s26, 0x30d4000
    s_mov_b32 s27, 0x00020000
    v_mov_b32 v242, 0x186a000
    v_and_b32 v243, 15, v1
    v_lshlrev_b32 v243, 2, v243
    v_and_b32 v22, 0xfffffe00, v244
    v_min_u32 v22, v22, v242
    v_lshl_add_u32 v22, v22, 1, v243
    v_and_b32 v23, 0xfffffe00, v245
    v_min_u32 v23, v23, v242
    v_lshl_add_u32 v23, v23, 1, v243
    v_and_b32 v24, 0xfffffe00, v246
    v_min_u32 v24, v24, v242
    v_lshl_add_u32 v24, v24, 1, v243
    v_and_b32 v25, 0xfffffe00, v247
    v_min_u32 v25, v25, v242
    v_lshl_add_u32 v25, v25, 1, v243
    s_bitcmp1_b32 s94, 0
    s_cbranch_scc1 LB_multi_st
    buffer_load_dword v114, v22, s[24:27], 0 offen offset:0 sc1
    buffer_load_dword v115, v23, s[24:27], 0 offen offset:0 sc1
    buffer_load_dword v116, v24, s[24:27], 0 offen offset:0 sc1
    buffer_load_dword v117, v25, s[24:27], 0 offen offset:0 sc1
    buffer_load_dword v118, v22, s[24:27], 0 offen offset:64 sc1
    buffer_load_dword v119, v23, s[24:27], 0 offen offset:64 sc1
    buffer_load_dword v120, v24, s[24:27], 0 offen offset:64 sc1
    buffer_load_dword v121, v25, s[24:27], 0 offen offset:64 sc1
    buffer_load_dword v122, v22, s[24:27], 0 offen offset:128 sc1
    buffer_load_dword v123, v23, s[24:27], 0 offen offset:128 sc1
    buffer_load_dword v124, v24, s[24:27], 0 offen offset:128 sc1
    buffer_load_dword v125, v25, s[24:27], 0 offen offset:128 sc1
    buffer_load_dword v126, v22, s[24:27], 0 offen offset:192 sc1
    buffer_load_dword v127, v23, s[24:27], 0 offen offset:192 sc1
    buffer_load_dword v128, v24, s[24:27], 0 offen offset:192 sc1
    buffer_load_dword v129, v25, s[24:27], 0 offen offset:192 sc1
    s_waitcnt vmcnt(0)
    v_add_f32 v130, v130, v114
    v_add_f32 v131, v131, v115
    v_add_f32 v132, v132, v116
    v_add_f32 v133, v133, v117
    v_add_f32 v134, v134, v118
    v_add_f32 v135, v135, v119
    v_add_f32 v136, v136, v120
    v_add_f32 v137, v137, v121
    v_add_f32 v138, v138, v122
    v_add_f32 v139, v139, v123
    v_add_f32 v140, v140, v124
    v_add_f32 v141, v141, v125
    v_add_f32 v142, v142, v126
    v_add_f32 v143, v143, v127
    v_add_f32 v144, v144, v128
    v_add_f32 v145, v145, v129
    buffer_load_dword v114, v22, s[24:27], 0 offen offset:256 sc1
    buffer_load_dword v115, v23, s[24:27], 0 offen offset:256 sc1
    buffer_load_dword v116, v24, s[24:27], 0 offen offset:256 sc1
    buffer_load_dword v117, v25, s[24:27], 0 offen offset:256 sc1
    buffer_load_dword v118, v22, s[24:27], 0 offen offset:320 sc1
    buffer_load_dword v119, v23, s[24:27], 0 offen offset:320 sc1
    buffer_load_dword v120, v24, s[24:27], 0 offen offset:320 sc1
    buffer_load_dword v121, v25, s[24:27], 0 offen offset:320 sc1
    buffer_load_dword v122, v22, s[24:27], 0 offen offset:384 sc1
    buffer_load_dword v123, v23, s[24:27], 0 offen offset:384 sc1
    buffer_load_dword v124, v24, s[24:27], 0 offen offset:384 sc1
    buffer_load_dword v125, v25, s[24:27], 0 offen offset:384 sc1
    buffer_load_dword v126, v22, s[24:27], 0 offen offset:448 sc1
    buffer_load_dword v127, v23, s[24:27], 0 offen offset:448 sc1
    buffer_load_dword v128, v24, s[24:27], 0 offen offset:448 sc1
    buffer_load_dword v129, v25, s[24:27], 0 offen offset:448 sc1
    s_waitcnt vmcnt(0)
    v_add_f32 v146, v146, v114
    v_add_f32 v147, v147, v115
    v_add_f32 v148, v148, v116
    v_add_f32 v149, v149, v117
    v_add_f32 v150, v150, v118
    v_add_f32 v151, v151, v119
    v_add_f32 v152, v152, v120
    v_add_f32 v153, v153, v121
    v_add_f32 v154, v154, v122
    v_add_f32 v155, v155, v123
    v_add_f32 v156, v156, v124
    v_add_f32 v157, v157, v125
    v_add_f32 v158, v158, v126
    v_add_f32 v159, v159, v127
    v_add_f32 v160, v160, v128
    v_add_f32 v161, v161, v129
    buffer_load_dword v114, v22, s[24:27], 0 offen offset:512 sc1
    buffer_load_dword v115, v23, s[24:27], 0 offen offset:512 sc1
    buffer_load_dword v116, v24, s[24:27], 0 offen offset:512 sc1
    buffer_load_dword v117, v25, s[24:27], 0 offen offset:512 sc1
    buffer_load_dword v118, v22, s[24:27], 0 offen offset:576 sc1
    buffer_load_dword v119, v23, s[24:27], 0 offen offset:576 sc1
    buffer_load_dword v120, v24, s[24:27], 0 offen offset:576 sc1
    buffer_load_dword v121, v25, s[24:27], 0 offen offset:576 sc1
    buffer_load_dword v122, v22, s[24:27], 0 offen offset:640 sc1
    buffer_load_dword v123, v23, s[24:27], 0 offen offset:640 sc1
    buffer_load_dword v124, v24, s[24:27], 0 offen offset:640 sc1
    buffer_load_dword v125, v25, s[24:27], 0 offen offset:640 sc1
    buffer_load_dword v126, v22, s[24:27], 0 offen offset:704 sc1
    buffer_load_dword v127, v23, s[24:27], 0 offen offset:704 sc1
    buffer_load_dword v128, v24, s[24:27], 0 offen offset:704 sc1
    buffer_load_dword v129, v25, s[24:27], 0 offen offset:704 sc1
    s_waitcnt vmcnt(0)
    v_add_f32 v162, v162, v114
    v_add_f32 v163, v163, v115
    v_add_f32 v164, v164, v116
    v_add_f32 v165, v165, v117
    v_add_f32 v166, v166, v118
    v_add_f32 v167, v167, v119
    v_add_f32 v168, v168, v120
    v_add_f32 v169, v169, v121
    v_add_f32 v170, v170, v122
    v_add_f32 v171, v171, v123
    v_add_f32 v172, v172, v124
    v_add_f32 v173, v173, v125
    v_add_f32 v174, v174, v126
    v_add_f32 v175, v175, v127
    v_add_f32 v176, v176, v128
    v_add_f32 v177, v177, v129
    buffer_load_dword v114, v22, s[24:27], 0 offen offset:768 sc1
    buffer_load_dword v115, v23, s[24:27], 0 offen offset:768 sc1
    buffer_load_dword v116, v24, s[24:27], 0 offen offset:768 sc1
    buffer_load_dword v117, v25, s[24:27], 0 offen offset:768 sc1
    buffer_load_dword v118, v22, s[24:27], 0 offen offset:832 sc1
    buffer_load_dword v119, v23, s[24:27], 0 offen offset:832 sc1
    buffer_load_dword v120, v24, s[24:27], 0 offen offset:832 sc1
    buffer_load_dword v121, v25, s[24:27], 0 offen offset:832 sc1
    buffer_load_dword v122, v22, s[24:27], 0 offen offset:896 sc1
    buffer_load_dword v123, v23, s[24:27], 0 offen offset:896 sc1
    buffer_load_dword v124, v24, s[24:27], 0 offen offset:896 sc1
    buffer_load_dword v125, v25, s[24:27], 0 offen offset:896 sc1
    buffer_load_dword v126, v22, s[24:27], 0 offen offset:960 sc1
    buffer_load_dword v127, v23, s[24:27], 0 offen offset:960 sc1
    buffer_load_dword v128, v24, s[24:27], 0 offen offset:960 sc1
    buffer_load_dword v129, v25, s[24:27], 0 offen offset:960 sc1
    s_waitcnt vmcnt(0)
    v_add_f32 v178, v178, v114
    v_add_f32 v179, v179, v115
    v_add_f32 v180, v180, v116
    v_add_f32 v181, v181, v117
    v_add_f32 v182, v182, v118
    v_add_f32 v183, v183, v119
    v_add_f32 v184, v184, v120
    v_add_f32 v185, v185, v121
    v_add_f32 v186, v186, v122
    v_add_f32 v187, v187, v123
    v_add_f32 v188, v188, v124
    v_add_f32 v189, v189, v125
    v_add_f32 v190, v190, v126
    v_add_f32 v191, v191, v127
    v_add_f32 v192, v192, v128
    v_add_f32 v193, v193, v129
    s_bitcmp1_b32 s94, 1
    s_cbranch_scc0 LB_multi_st
    s_mov_b32 s97, 0xbfb8aa3b
    v_mul_f32 v58, s97, v130
    v_mul_f32 v59, s97, v131
    v_mul_f32 v60, s97, v132
    v_mul_f32 v61, s97, v133
    v_mul_f32 v62, s97, v134
    v_mul_f32 v63, s97, v135
    v_mul_f32 v64, s97, v136
    v_mul_f32 v65, s97, v137
    v_mul_f32 v26, s97, v138
    v_mul_f32 v27, s97, v139
    v_mul_f32 v28, s97, v140
    v_mul_f32 v29, s97, v141
    v_mul_f32 v30, s97, v142
    v_mul_f32 v31, s97, v143
    v_mul_f32 v32, s97, v144
    v_mul_f32 v33, s97, v145
    v_exp_f32 v58, v58
    v_exp_f32 v59, v59
    v_exp_f32 v60, v60
    v_exp_f32 v61, v61
    v_exp_f32 v62, v62
    v_exp_f32 v63, v63
    v_exp_f32 v64, v64
    v_exp_f32 v65, v65
    v_exp_f32 v26, v26
    v_exp_f32 v27, v27
    v_exp_f32 v28, v28
    v_exp_f32 v29, v29
    v_exp_f32 v30, v30
    v_exp_f32 v31, v31
    v_exp_f32 v32, v32
    v_exp_f32 v33, v33
    v_add_f32 v58, 1.0, v58
    v_add_f32 v59, 1.0, v59
    v_add_f32 v60, 1.0, v60
    v_add_f32 v61, 1.0, v61
    v_add_f32 v62, 1.0, v62
    v_add_f32 v63, 1.0, v63
    v_add_f32 v64, 1.0, v64
    v_add_f32 v65, 1.0, v65
    v_add_f32 v26, 1.0, v26
    v_add_f32 v27, 1.0, v27
    v_add_f32 v28, 1.0, v28
    v_add_f32 v29, 1.0, v29
    v_add_f32 v30, 1.0, v30
    v_add_f32 v31, 1.0, v31
    v_add_f32 v32, 1.0, v32
    v_add_f32 v33, 1.0, v33
    v_rcp_f32 v58, v58
    v_rcp_f32 v59, v59
    v_rcp_f32 v60, v60
    v_rcp_f32 v61, v61
    v_rcp_f32 v62, v62
    v_rcp_f32 v63, v63
    v_rcp_f32 v64, v64
    v_rcp_f32 v65, v65
    v_rcp_f32 v26, v26
    v_rcp_f32 v27, v27
    v_rcp_f32 v28, v28
    v_rcp_f32 v29, v29
    v_rcp_f32 v30, v30
    v_rcp_f32 v31, v31
    v_rcp_f32 v32, v32
    v_rcp_f32 v33, v33
    s_mov_b32 s18, 0x186a000
    v_cvt_pk_bf16_f32 v66, v130, v134
    v_cvt_pk_bf16_f32 v67, v131, v135
    v_cvt_pk_bf16_f32 v68, v132, v136
    v_cvt_pk_bf16_f32 v69, v133, v137
    v_cvt_pk_bf16_f32 v82, v138, v142
    v_cvt_pk_bf16_f32 v83, v139, v143
    v_cvt_pk_bf16_f32 v84, v140, v144
    v_cvt_pk_bf16_f32 v85, v141, v145
    buffer_store_dword v66, v244, s[16:19], 0 offen offset:0 sc1
    buffer_store_dword v67, v245, s[16:19], 0 offen offset:0 sc1
    buffer_store_dword v68, v246, s[16:19], 0 offen offset:0 sc1
    buffer_store_dword v69, v247, s[16:19], 0 offen offset:0 sc1
    buffer_store_dword v82, v244, s[16:19], 0 offen offset:64 sc1
    buffer_store_dword v83, v245, s[16:19], 0 offen offset:64 sc1
    buffer_store_dword v84, v246, s[16:19], 0 offen offset:64 sc1
    buffer_store_dword v85, v247, s[16:19], 0 offen offset:64 sc1
    v_mul_f32 v2, v146, v58
    v_mul_f32 v3, v147, v59
    v_mul_f32 v4, v148, v60
    v_mul_f32 v5, v149, v61
    v_mul_f32 v10, v150, v62
    v_mul_f32 v11, v151, v63
    v_mul_f32 v12, v152, v64
    v_mul_f32 v13, v153, v65
    v_cvt_pk_bf16_f32 v34, v2, v10
    v_cvt_pk_bf16_f32 v35, v3, v11
    v_cvt_pk_bf16_f32 v36, v4, v12
    v_cvt_pk_bf16_f32 v37, v5, v13
    buffer_store_dword v34, v244, s[16:19], 0 offen offset:128 sc1
    buffer_store_dword v35, v245, s[16:19], 0 offen offset:128 sc1
    buffer_store_dword v36, v246, s[16:19], 0 offen offset:128 sc1
    buffer_store_dword v37, v247, s[16:19], 0 offen offset:128 sc1
    v_mul_f32 v2, v162, v58
    v_mul_f32 v3, v163, v59
    v_mul_f32 v4, v164, v60
    v_mul_f32 v5, v165, v61
    v_mul_f32 v10, v166, v62
    v_mul_f32 v11, v167, v63
    v_mul_f32 v12, v168, v64
    v_mul_f32 v13, v169, v65
    v_cvt_pk_bf16_f32 v42, v2, v10
    v_cvt_pk_bf16_f32 v43, v3, v11
    v_cvt_pk_bf16_f32 v44, v4, v12
    v_cvt_pk_bf16_f32 v45, v5, v13
    buffer_store_dword v42, v244, s[16:19], 0 offen offset:256 sc1
    buffer_store_dword v43, v245, s[16:19], 0 offen offset:256 sc1
    buffer_store_dword v44, v246, s[16:19], 0 offen offset:256 sc1
    buffer_store_dword v45, v247, s[16:19], 0 offen offset:256 sc1
    v_mul_f32 v2, v178, v58
    v_mul_f32 v3, v179, v59
    v_mul_f32 v4, v180, v60
    v_mul_f32 v5, v181, v61
    v_mul_f32 v10, v182, v62
    v_mul_f32 v11, v183, v63
    v_mul_f32 v12, v184, v64
    v_mul_f32 v13, v185, v65
    v_cvt_pk_bf16_f32 v50, v2, v10
    v_cvt_pk_bf16_f32 v51, v3, v11
    v_cvt_pk_bf16_f32 v52, v4, v12
    v_cvt_pk_bf16_f32 v53, v5, v13
    buffer_store_dword v50, v244, s[16:19], 0 offen offset:384 sc1
    buffer_store_dword v51, v245, s[16:19], 0 offen offset:384 sc1
    buffer_store_dword v52, v246, s[16:19], 0 offen offset:384 sc1
    buffer_store_dword v53, v247, s[16:19], 0 offen offset:384 sc1
    s_branch LB_gate
LB_multi_st:
    buffer_store_dword v130, v22, s[24:27], 0 offen offset:0
    buffer_store_dword v131, v23, s[24:27], 0 offen offset:0
    buffer_store_dword v132, v24, s[24:27], 0 offen offset:0
    buffer_store_dword v133, v25, s[24:27], 0 offen offset:0
    buffer_store_dword v134, v22, s[24:27], 0 offen offset:64
    buffer_store_dword v135, v23, s[24:27], 0 offen offset:64
    buffer_store_dword v136, v24, s[24:27], 0 offen offset:64
    buffer_store_dword v137, v25, s[24:27], 0 offen offset:64
    buffer_store_dword v138, v22, s[24:27], 0 offen offset:128
    buffer_store_dword v139, v23, s[24:27], 0 offen offset:128
    buffer_store_dword v140, v24, s[24:27], 0 offen offset:128
    buffer_store_dword v141, v25, s[24:27], 0 offen offset:128
    buffer_store_dword v142, v22, s[24:27], 0 offen offset:192
    buffer_store_dword v143, v23, s[24:27], 0 offen offset:192
    buffer_store_dword v144, v24, s[24:27], 0 offen offset:192
    buffer_store_dword v145, v25, s[24:27], 0 offen offset:192
    s_waitcnt vmcnt(0)
    buffer_store_dword v146, v22, s[24:27], 0 offen offset:256
    buffer_store_dword v147, v23, s[24:27], 0 offen offset:256
    buffer_store_dword v148, v24, s[24:27], 0 offen offset:256
    buffer_store_dword v149, v25, s[24:27], 0 offen offset:256
    buffer_store_dword v150, v22, s[24:27], 0 offen offset:320
    buffer_store_dword v151, v23, s[24:27], 0 offen offset:320
    buffer_store_dword v152, v24, s[24:27], 0 offen offset:320
    buffer_store_dword v153, v25, s[24:27], 0 offen offset:320
    buffer_store_dword v154, v22, s[24:27], 0 offen offset:384
    buffer_store_dword v155, v23, s[24:27], 0 offen offset:384
    buffer_store_dword v156, v24, s[24:27], 0 offen offset:384
    buffer_store_dword v157, v25, s[24:27], 0 offen offset:384
    buffer_store_dword v158, v22, s[24:27], 0 offen offset:448
    buffer_store_dword v159, v23, s[24:27], 0 offen offset:448
    buffer_store_dword v160, v24, s[24:27], 0 offen offset:448
    buffer_store_dword v161, v25, s[24:27], 0 offen offset:448
    s_waitcnt vmcnt(0)
    buffer_store_dword v162, v22, s[24:27], 0 offen offset:512
    buffer_store_dword v163, v23, s[24:27], 0 offen offset:512
    buffer_store_dword v164, v24, s[24:27], 0 offen offset:512
    buffer_store_dword v165, v25, s[24:27], 0 offen offset:512
    buffer_store_dword v166, v22, s[24:27], 0 offen offset:576
    buffer_store_dword v167, v23, s[24:27], 0 offen offset:576
    buffer_store_dword v168, v24, s[24:27], 0 offen offset:576
    buffer_store_dword v169, v25, s[24:27], 0 offen offset:576
    buffer_store_dword v170, v22, s[24:27], 0 offen offset:640
    buffer_store_dword v171, v23, s[24:27], 0 offen offset:640
    buffer_store_dword v172, v24, s[24:27], 0 offen offset:640
    buffer_store_dword v173, v25, s[24:27], 0 offen offset:640
    buffer_store_dword v174, v22, s[24:27], 0 offen offset:704
    buffer_store_dword v175, v23, s[24:27], 0 offen offset:704
    buffer_store_dword v176, v24, s[24:27], 0 offen offset:704
    buffer_store_dword v177, v25, s[24:27], 0 offen offset:704
    s_waitcnt vmcnt(0)
    buffer_store_dword v178, v22, s[24:27], 0 offen offset:768
    buffer_store_dword v179, v23, s[24:27], 0 offen offset:768
    buffer_store_dword v180, v24, s[24:27], 0 offen offset:768
    buffer_store_dword v181, v25, s[24:27], 0 offen offset:768
    buffer_store_dword v182, v22, s[24:27], 0 offen offset:832
    buffer_store_dword v183, v23, s[24:27], 0 offen offset:832
    buffer_store_dword v184, v24, s[24:27], 0 offen offset:832
    buffer_store_dword v185, v25, s[24:27], 0 offen offset:832
    buffer_store_dword v186, v22, s[24:27], 0 offen offset:896
    buffer_store_dword v187, v23, s[24:27], 0 offen offset:896
    buffer_store_dword v188, v24, s[24:27], 0 offen offset:896
    buffer_store_dword v189, v25, s[24:27], 0 offen offset:896
    buffer_store_dword v190, v22, s[24:27], 0 offen offset:960
    buffer_store_dword v191, v23, s[24:27], 0 offen offset:960
    buffer_store_dword v192, v24, s[24:27], 0 offen offset:960
    buffer_store_dword v193, v25, s[24:27], 0 offen offset:960
    s_waitcnt vmcnt(0)
    s_branch LB_round_end
LB_meet0:
    s_barrier
LB_acted0:
    s_lshr_b64 s[42:43], s[42:43], 8
    s_and_b32 s89, s42, 255
    s_cmp_eq_u32 s84, s89
    s_cbranch_scc1 LB_meet0
    s_branch LB_met0
LB_meet1:
    s_barrier
LB_acted1:
    s_lshr_b64 s[42:43], s[42:43], 8
    s_and_b32 s89, s42, 255
    s_cmp_eq_u32 s84, s89
    s_cbranch_scc1 LB_meet1
    s_branch LB_met1
LB_meet2:
    s_barrier
LB_acted2:
    s_lshr_b64 s[42:43], s[42:43], 8
    s_and_b32 s89, s42, 255
    s_cmp_eq_u32 s84, s89
    s_cbranch_scc1 LB_meet2
    s_branch LB_met2
LB_end:
    s_endpgm
.section .rodata,"a"
.p2align 6
.amdhsa_kernel part_kernel
  .amdhsa_next_free_vgpr 64
  .amdhsa_next_free_sgpr 64
  .amdhsa_accum_offset 64
  .amdhsa_group_segment_fixed_size 0
  .amdhsa_kernarg_size 96
  .amdhsa_user_sgpr_count 2
  .amdhsa_user_sgpr_kernarg_segment_ptr 1
  .amdhsa_system_sgpr_workgroup_id_x 1
  .amdhsa_float_denorm_mode_32 3
.end_amdhsa_kernel
.p2align 6
.amdhsa_kernel standalone__tensor_product_equiv_equiformer__graph_kernel
  .amdhsa_next_free_vgpr 254
  .amdhsa_next_free_sgpr 99
  .amdhsa_accum_offset 256
  .amdhsa_group_segment_fixed_size 0
  .amdhsa_kernarg_size 96
  .amdhsa_user_sgpr_count 2
  .amdhsa_user_sgpr_kernarg_segment_ptr 1
  .amdhsa_system_sgpr_workgroup_id_x 1
  .amdhsa_float_denorm_mode_32 3
.end_amdhsa_kernel
```
